```python
import torch

def _softmax(x, axis=-1):
    return torch.softmax(x, dim=axis)
def _gelu(x):
    return torch.nn.functional.gelu(x, approximate="tanh")
def _silu(x):
    return torch.nn.functional.silu(x)
def _sigmoid(x):
    return torch.sigmoid(x)
def _layernorm(x, axis=-1, eps=1e-5):
    m = x.mean(dim=axis, keepdim=True)
    v = x.var(dim=axis, keepdim=True, unbiased=False)
    return (x - m) / torch.sqrt(v + eps)
def _scatter_add(tgt, idx, src, axis=0):
    return tgt.clone().index_add_(axis, idx, src)
def _segment_sum(src, seg, n):
    out = torch.zeros((n,) + src.shape[1:], dtype=src.dtype)
    return out.index_add_(0, seg, src)
def _pad(x, pw):
    flat = tuple(v for pair in reversed(pw) for v in pair)
    return torch.nn.functional.pad(x, flat)

kernel_name = 'recurrent_scan__ssm_conv_h3__mixer_s_mlp__prompt'

def setup_inputs():

    _w = (lambda a: (lambda t: t.to(torch.bfloat16) if t.is_floating_point() else t)(torch.as_tensor(a)))
    def _A_setup():
        B, S, D = 1, 2048, 640
        ks = 4
        return {
            "q": _w((lambda *s: torch.randn(*s, dtype=torch.bfloat16) * 0.05)(B, S, D)),
            "k": _w((lambda *s: torch.randn(*s, dtype=torch.bfloat16) * 0.2)(B, S, D)),
            "v": _w((lambda *s: torch.randn(*s, dtype=torch.bfloat16) * 0.2)(B, S, D)),
            "shift_k": _w((lambda *s: torch.randn(*s, dtype=torch.bfloat16) * 0.2)(D, ks) * 0.5),
            "ssm_k": _w((lambda *s: torch.randn(*s, dtype=torch.bfloat16) * 0.2)(D, S) * (1.0 / S ** 0.5)),
            "ssm_D": _w((lambda *s: torch.randn(*s, dtype=torch.bfloat16) * 0.2)(D)),
        }
    _A_in = _A_setup()

    def _B_setup():
        B, S, D, F = 1, 2048, 640, 1728
        return {
            "x":  _w((lambda *s: torch.randn(*s, dtype=torch.bfloat16) * 0.05)(B, S, D)),
            "w1": _w((lambda *s: torch.randn(*s, dtype=torch.bfloat16) * 3.2)(D, D) * (D ** -0.5)),
            "w2": _w((lambda *s: torch.randn(*s, dtype=torch.bfloat16) * 3.2)(D, D) * (D ** -0.5)),
            "w3": _w((lambda *s: torch.randn(*s, dtype=torch.bfloat16) * 3.2)(D, F) * (D ** -0.5)),
            "w4": _w((lambda *s: torch.randn(*s, dtype=torch.bfloat16) * 3.2)(F, D) * (F ** -0.5)),
        }
    _B_in = _B_setup()

    return {
        "A_q": _A_in["q"],
        "A_k": _A_in["k"],
        "A_v": _A_in["v"],
        "A_shift_k": _A_in["shift_k"],
        "A_ssm_k": _A_in["ssm_k"],
        "A_ssm_D": _A_in["ssm_D"],
        "B_x": _B_in["x"],
        "B_w1": _B_in["w1"],
        "B_w2": _B_in["w2"],
        "B_w3": _B_in["w3"],
        "B_w4": _B_in["w4"],
    }

def reference(A_q, A_k, A_v, A_shift_k, A_ssm_k, A_ssm_D, B_x, B_w1, B_w2, B_w3, B_w4):
    def _A_ref(q, k, v, shift_k, ssm_k, ssm_D):
        B, S, D = q.shape
        ks = shift_k.shape[-1]
        k_pad = _pad(k, ((0, 0), (ks - 1, 0), (0, 0)))
        k_shift = torch.zeros_like(k)
        for t in range(ks):
            k_shift = k_shift + k_pad[:, t:t + S, :] * shift_k[:, ks - 1 - t][None, None, :]
        kv = k_shift * v
        L = 2 * S
        kv_pad = _pad(kv, ((0, 0), (0, S), (0, 0)))
        kf_pad = _pad(ssm_k, ((0, 0), (0, S)))
        kv_f = (lambda x, axes=(-2,-1): torch.fft.rfft2(x.float(), dim=axes))(kv_pad[:, None, :, :], axes=(1, 2))
        kf_f = (lambda x, axes=(-2,-1): torch.fft.rfft2(x.float(), dim=axes))(kf_pad[:, None, :], axes=(1, 2))
        kf_f = (lambda x, *d: x.permute(*d))(kf_f, 1, 2, 0)
        y_f = kv_f * kf_f[None, :, :, :]
        y = (lambda x, s, axes=(-2,-1): torch.fft.irfft2(x, s=s, dim=axes).to(torch.bfloat16))(y_f, (1, L), axes=(1, 2))[:, 0, :S, :]
        y = y + kv * ssm_D[None, None, :]
        return q * y

    def _B_ref(x, w1, w2, w3, w4):
        B, S, D = x.shape
        h = _gelu(_layernorm(x, axis=-1) @ w1)
        c = D // 4
        g0 = _pad(h[:, :, 0*c:1*c], ((0, 0), (1, 0), (0, 0)))[:, :S, :]
        g1 = _pad(h[:, :, 1*c:2*c], ((0, 0), (0, 1), (0, 0)))[:, 1:, :]
        g2 = _pad(h[:, :, 2*c:3*c], ((0, 0), (2, 0), (0, 0)))[:, :S, :]
        g3 = _pad(h[:, :, 3*c:   ], ((0, 0), (0, 2), (0, 0)))[:, 2:, :]
        hs = torch.concatenate([g0, g1, g2, g3], axis=-1) @ w2
        x1 = x + hs
        h2 = _gelu(_layernorm(x1, axis=-1) @ w3) @ w4
        return x1 + h2

    x = A_q
    xn = _layernorm(x, axis=-1)
    s = _A_ref(xn, A_k, A_v, A_shift_k, A_ssm_k, A_ssm_D)
    g = _silu(_B_ref(xn, B_w1, B_w2, B_w3, B_w4))
    return x + s * g
```

```asm
; @launch grid=(256,1,1) block=(256,1,1) lds=163840
.amdgcn_target "amdgcn-amd-amdhsa--gfx950"
.text
.globl recurrent_scan__ssm_conv_h3__mixer_s_mlp__prompt_kernel
.p2align 8
.type recurrent_scan__ssm_conv_h3__mixer_s_mlp__prompt_kernel,@function
recurrent_scan__ssm_conv_h3__mixer_s_mlp__prompt_kernel:
    s_cmp_ge_u32 s2, 256
    s_cbranch_scc1 L_end
    s_getpc_b64 s[76:77]
    v_lshlrev_b32 v10, 7, v0
    v_cmp_gt_u32 vcc, 48, v0
    s_and_saveexec_b64 s[74:75], vcc
    s_cbranch_execz L_ncp0_1
    global_load_dword v254, v10, s[76:77]
L_ncp0_1:
    s_mov_b64 exec, -1
    s_load_dwordx2 s[4:5], s[0:1], 0
    s_mov_b32 s6, 0x280000
    s_mov_b32 s7, 0x20000
    s_load_dwordx2 s[16:17], s[0:1], 56
    s_mov_b32 s18, 0xc8000
    s_mov_b32 s19, 0x20000
    s_load_dwordx2 s[36:37], s[0:1], 104
    s_mov_b32 s38, 0x10000000
    s_mov_b32 s39, 0x20000
    s_load_dwordx2 s[48:49], s[0:1], 96
    s_mov_b32 s50, 0x100
    s_mov_b32 s51, 0x20000
    s_load_dwordx2 s[20:21], s[0:1], 64
    s_mov_b32 s22, 0xc8000
    s_mov_b32 s23, 0x20000
    s_memrealtime s[64:65]
    v_and_b32 v1, 63, v0
    v_lshrrev_b32 v9, 6, v0
    v_and_b32 v2, 15, v1
    v_readfirstlane_b32 s58, v9
    v_lshrrev_b32 v3, 4, v1
    v_lshlrev_b32 v4, 4, v1
    s_and_b32 s56, s2, 7
    s_lshl_b32 s56, s56, 2
    s_lshr_b32 s57, s2, 6
    s_add_u32 s56, s56, s57
    s_bfe_u32 s57, s2, 0x30003
    s_lshl_b32 s75, s57, 2
    s_add_u32 s75, s75, s58
    s_mul_i32 s75, s75, 2560
    s_mul_i32 s76, s56, 81920
    s_add_u32 s75, s75, s76
    v_lshlrev_b32 v10, 7, v1
    s_lshr_b32 s3, s2, 3
    s_lshl_b32 s3, s3, 2
    s_add_u32 s3, s3, s58
    s_mul_i32 s3, s3, 6400
    s_waitcnt lgkmcnt(0)
    s_mov_b64 exec, 0xfffff
    buffer_load_dword v0, v10, s[4:7], s75 offen nt
    s_mov_b32 exec_lo, -1
    s_mov_b32 exec_hi, 0x3ffff
    s_lshl_b32 s75, s2, 2
    s_add_u32 s75, s75, s58
    s_mul_i32 s75, s75, 896
    s_mov_b64 exec, 0x7f
    buffer_load_dword v0, v10, s[16:19], s75 offen
    s_lshl_b32 s75, s2, 2
    s_add_u32 s75, s75, s58
    s_mul_i32 s75, s75, 896
    s_mov_b64 exec, 0x7f
    buffer_load_dword v0, v10, s[20:23], s75 offen
    s_mov_b64 exec, -1
    s_load_dwordx2 s[8:9], s[0:1], 8
    s_mov_b32 s10, 0x280000
    s_mov_b32 s11, 0x20000
    s_load_dwordx2 s[12:13], s[0:1], 16
    s_mov_b32 s14, 0x280000
    s_mov_b32 s15, 0x20000
    s_load_dwordx2 s[44:45], s[0:1], 24
    s_mov_b32 s46, 0x1400
    s_mov_b32 s47, 0x20000
    s_load_dwordx2 s[40:41], s[0:1], 32
    s_mov_b32 s42, 0x1000
    s_mov_b32 s43, 0x20000
    s_load_dwordx2 s[24:25], s[0:1], 72
    s_mov_b32 s26, 0x21c000
    s_mov_b32 s27, 0x20000
    s_load_dwordx2 s[28:29], s[0:1], 80
    s_mov_b32 s30, 0x21c000
    s_mov_b32 s31, 0x20000
    s_load_dwordx2 s[32:33], s[0:1], 88
    s_mov_b32 s34, 0x280000
    s_mov_b32 s35, 0x20000
    s_load_dwordx2 s[72:73], s[0:1], 40
    s_cmp_lg_u32 s58, 3
    s_cbranch_scc1 L_nocpf_2
    s_getpc_b64 s[76:77]
L_pc:
    s_lshr_b32 s75, s2, 3
    s_mul_i32 s75, s75, 1408
    v_add_u32 v10, s75, v10
    v_min_u32 v10, L_end-L_pc, v10
    s_mov_b64 exec, 0x7ff
    global_load_dword v0, v10, s[76:77]
    s_mov_b64 exec, -1
L_nocpf_2:
    s_or_b32 s76, s2, s58
    s_cmp_lg_u32 s76, 0
    s_cbranch_scc1 L_nononce_3
    s_or_b32 s65, s65, 0x40000000
    v_mov_b32 v10, s64
    v_mov_b32 v11, s65
    v_mov_b32 v9, 0
    s_mov_b64 exec, 1
    buffer_store_dwordx2 v[10:11], v9, s[48:51], 0 offen sc1
    s_mov_b64 exec, -1
L_nononce_3:
    s_mov_b32 s63, 0xffff0000
    s_mov_b32 s93, 1280
    s_mov_b32 s69, s58
    s_add_u32 s66, s69, 1
    s_and_b32 s66, s66, 3
    s_add_u32 s67, s69, 2
    s_and_b32 s67, s67, 3
    s_add_u32 s68, s69, 3
    s_and_b32 s68, s68, 3
    s_mul_i32 s61, s69, 15360
    s_mul_i32 s86, s58, 20480
    s_add_u32 s92, s86, 81920
    s_mul_i32 s97, s58, 5120
    s_add_u32 s97, s97, 61440
    s_mul_i32 s62, s58, 25600
    s_sub_u32 s62, 138240, s62
    s_lshl_b32 s96, s56, 2
    s_add_u32 s96, s96, s69
    s_mul_i32 s87, s96, 20480
    s_lshl_b32 s96, s96, 4
    s_lshl_b32 s74, s57, 1
    s_add_u32 s74, s74, s56
    s_and_b32 s3, s74, 0
    s_mul_i32 s85, s58, 204800
    s_mul_i32 s70, s57, 160
    s_add_u32 s85, s85, s70
    v_add_u32 v9, 0, v1
    v_mul_u32_u24 v10, 820, v9
    v_lshrrev_b32 v10, 16, v10
    v_mul_u32_u24 v11, 80, v10
    v_sub_u32 v9, v9, v11
    v_xor_b32 v9, v9, v10
    v_lshlrev_b32 v9, 4, v9
    v_mad_u32_u24 v160, v10, s93, v9
    v_add_u32 v9, 64, v1
    v_mul_u32_u24 v10, 820, v9
    v_lshrrev_b32 v10, 16, v10
    v_mul_u32_u24 v11, 80, v10
    v_sub_u32 v9, v9, v11
    v_xor_b32 v9, v9, v10
    v_lshlrev_b32 v9, 4, v9
    v_mad_u32_u24 v161, v10, s93, v9
    v_add_u32 v9, 128, v1
    v_mul_u32_u24 v10, 820, v9
    v_lshrrev_b32 v10, 16, v10
    v_mul_u32_u24 v11, 80, v10
    v_sub_u32 v9, v9, v11
    v_xor_b32 v9, v9, v10
    v_lshlrev_b32 v9, 4, v9
    v_mad_u32_u24 v162, v10, s93, v9
    v_add_u32 v9, 192, v1
    v_mul_u32_u24 v10, 820, v9
    v_lshrrev_b32 v10, 16, v10
    v_mul_u32_u24 v11, 80, v10
    v_sub_u32 v9, v9, v11
    v_xor_b32 v9, v9, v10
    v_lshlrev_b32 v9, 4, v9
    v_mad_u32_u24 v163, v10, s93, v9
    v_add_u32 v9, 256, v1
    v_mul_u32_u24 v10, 820, v9
    v_lshrrev_b32 v10, 16, v10
    v_mul_u32_u24 v11, 80, v10
    v_sub_u32 v9, v9, v11
    v_xor_b32 v9, v9, v10
    v_lshlrev_b32 v9, 4, v9
    v_mad_u32_u24 v164, v10, s93, v9
    v_add_u32 v9, 0, v1
    v_mul_u32_u24 v10, 6554, v9
    v_lshrrev_b32 v10, 16, v10
    v_mov_b32 v11, v10
    v_mul_u32_u24 v173, 10, v10
    v_sub_u32 v173, v9, v173
    v_bfe_u32 v9, v10, 2, 2
    v_and_b32 v168, 3, v10
    v_lshl_add_u32 v168, v9, 3, v168
    v_lshrrev_b32 v10, 4, v10
    v_lshl_add_u32 v168, v10, 2, v168
    v_lshlrev_b32 v9, 4, v173
    v_mad_u32_u24 v240, v168, s93, v9
    v_mad_u32_u24 v72, v11, s93, v9
    v_add_u32 v9, 64, v1
    v_mul_u32_u24 v10, 6554, v9
    v_lshrrev_b32 v10, 16, v10
    v_mov_b32 v11, v10
    v_mul_u32_u24 v174, 10, v10
    v_sub_u32 v174, v9, v174
    v_bfe_u32 v9, v10, 2, 2
    v_and_b32 v169, 3, v10
    v_lshl_add_u32 v169, v9, 3, v169
    v_lshrrev_b32 v10, 4, v10
    v_lshl_add_u32 v169, v10, 2, v169
    v_lshlrev_b32 v9, 4, v174
    v_mad_u32_u24 v241, v169, s93, v9
    v_mad_u32_u24 v73, v11, s93, v9
    v_add_u32 v9, 128, v1
    v_mul_u32_u24 v10, 6554, v9
    v_lshrrev_b32 v10, 16, v10
    v_mov_b32 v11, v10
    v_mul_u32_u24 v175, 10, v10
    v_sub_u32 v175, v9, v175
    v_bfe_u32 v9, v10, 2, 2
    v_and_b32 v170, 3, v10
    v_lshl_add_u32 v170, v9, 3, v170
    v_lshrrev_b32 v10, 4, v10
    v_lshl_add_u32 v170, v10, 2, v170
    v_lshlrev_b32 v9, 4, v175
    v_mad_u32_u24 v242, v170, s93, v9
    v_mad_u32_u24 v74, v11, s93, v9
    v_add_u32 v9, 192, v1
    v_mul_u32_u24 v10, 6554, v9
    v_lshrrev_b32 v10, 16, v10
    v_mov_b32 v11, v10
    v_mul_u32_u24 v176, 10, v10
    v_sub_u32 v176, v9, v176
    v_bfe_u32 v9, v10, 2, 2
    v_and_b32 v171, 3, v10
    v_lshl_add_u32 v171, v9, 3, v171
    v_lshrrev_b32 v10, 4, v10
    v_lshl_add_u32 v171, v10, 2, v171
    v_lshlrev_b32 v9, 4, v176
    v_mad_u32_u24 v243, v171, s93, v9
    v_mad_u32_u24 v75, v11, s93, v9
    v_add_u32 v9, 256, v1
    v_mul_u32_u24 v10, 6554, v9
    v_lshrrev_b32 v10, 16, v10
    v_mov_b32 v11, v10
    v_mul_u32_u24 v177, 10, v10
    v_sub_u32 v177, v9, v177
    v_bfe_u32 v9, v10, 2, 2
    v_and_b32 v172, 3, v10
    v_lshl_add_u32 v172, v9, 3, v172
    v_lshrrev_b32 v10, 4, v10
    v_lshl_add_u32 v172, v10, 2, v172
    v_lshlrev_b32 v9, 4, v177
    v_mad_u32_u24 v244, v172, s93, v9
    s_lshr_b32 s74, s56, 1
    s_mul_i32 s74, s74, 5
    s_and_b32 s75, s56, 1
    s_mul_i32 s76, s75, 3
    s_add_u32 s74, s74, s76
    s_add_u32 s74, s74, s58
    s_mul_i32 s59, s57, 80
    s_add_u32 s59, s59, s74
    s_add_u32 s75, s75, s58
    s_cmp_lt_u32 s75, 3
    s_cselect_b32 s60, 1, 0
    s_cselect_b32 s59, s59, 0
    s_waitcnt lgkmcnt(0)
    s_lshr_b32 s75, s59, 1
    s_lshl_b32 s75, s75, 2
    s_load_dword s90, s[72:73], s75
    s_lshl_b32 s75, s59, 12
    s_add_u32 s40, s40, s75
    s_addc_u32 s41, s41, 0
    s_add_u32 s101, s87, 0
    s_add_u32 m0, s86, 0
    s_nop 0
    buffer_load_dwordx4 v160, s[4:7], s101 offen lds
    s_add_u32 m0, s86, 1024
    s_nop 0
    buffer_load_dwordx4 v161, s[4:7], s101 offen lds
    s_add_u32 m0, s86, 2048
    s_nop 0
    buffer_load_dwordx4 v162, s[4:7], s101 offen lds
    s_add_u32 m0, s86, 3072
    s_nop 0
    buffer_load_dwordx4 v163, s[4:7], s101 offen lds
    s_add_u32 m0, s86, 4096
    s_nop 0
    buffer_load_dwordx4 v164, s[4:7], s101 offen lds
    s_add_u32 s101, s87, 5120
    s_add_u32 m0, s86, 5120
    v_xor_b32 v19, 64, v160
    buffer_load_dwordx4 v19, s[4:7], s101 offen lds
    s_add_u32 m0, s86, 6144
    v_xor_b32 v19, 64, v161
    buffer_load_dwordx4 v19, s[4:7], s101 offen lds
    s_add_u32 m0, s86, 7168
    v_xor_b32 v19, 64, v162
    buffer_load_dwordx4 v19, s[4:7], s101 offen lds
    s_add_u32 m0, s86, 8192
    v_xor_b32 v19, 64, v163
    buffer_load_dwordx4 v19, s[4:7], s101 offen lds
    s_add_u32 m0, s86, 9216
    v_xor_b32 v19, 64, v164
    buffer_load_dwordx4 v19, s[4:7], s101 offen lds
    s_add_u32 s101, s87, 10240
    s_add_u32 m0, s86, 10240
    v_xor_b32 v19, 128, v160
    buffer_load_dwordx4 v19, s[4:7], s101 offen lds
    s_add_u32 m0, s86, 11264
    v_xor_b32 v19, 128, v161
    buffer_load_dwordx4 v19, s[4:7], s101 offen lds
    s_add_u32 m0, s86, 12288
    v_xor_b32 v19, 128, v162
    buffer_load_dwordx4 v19, s[4:7], s101 offen lds
    s_add_u32 m0, s86, 13312
    v_xor_b32 v19, 128, v163
    buffer_load_dwordx4 v19, s[4:7], s101 offen lds
    s_add_u32 m0, s86, 14336
    v_xor_b32 v19, 128, v164
    buffer_load_dwordx4 v19, s[4:7], s101 offen lds
    s_add_u32 s101, s87, 15360
    s_add_u32 m0, s86, 15360
    v_xor_b32 v19, 192, v160
    buffer_load_dwordx4 v19, s[4:7], s101 offen lds
    s_add_u32 m0, s86, 16384
    v_xor_b32 v19, 192, v161
    buffer_load_dwordx4 v19, s[4:7], s101 offen lds
    s_add_u32 m0, s86, 17408
    v_xor_b32 v19, 192, v162
    buffer_load_dwordx4 v19, s[4:7], s101 offen lds
    s_add_u32 m0, s86, 18432
    v_xor_b32 v19, 192, v163
    buffer_load_dwordx4 v19, s[4:7], s101 offen lds
    s_add_u32 m0, s86, 19456
    v_xor_b32 v19, 192, v164
    buffer_load_dwordx4 v19, s[4:7], s101 offen lds
    s_add_u32 s95, s3, 0
    s_and_b32 s95, s95, 3
    s_mul_i32 s95, s95, 40960
    s_add_u32 s95, s95, s85
    s_add_u32 m0, s92, 0
    s_nop 0
    buffer_load_dwordx4 v240, s[16:19], s95 offen lds
    s_add_u32 m0, s92, 1024
    s_nop 0
    buffer_load_dwordx4 v241, s[16:19], s95 offen lds
    s_add_u32 m0, s92, 2048
    s_nop 0
    buffer_load_dwordx4 v242, s[16:19], s95 offen lds
    s_add_u32 m0, s92, 3072
    s_nop 0
    buffer_load_dwordx4 v243, s[16:19], s95 offen lds
    s_cmp_ge_u32 s56, 20
    s_cbranch_scc1 L_u4_4
    s_cmp_eq_u32 s58, 3
    s_cbranch_scc1 L_u4_4
    s_mov_b32 s91, 3456
    s_mul_i32 s83, s56, 110592
    s_mul_i32 s70, s57, 384
    s_mul_i32 s71, s57, 3
    s_lshr_b32 s71, s71, 1
    s_lshl_b32 s71, s71, 5
    s_add_u32 s71, s71, 3072
    s_mul_i32 s72, s57, 245760
    s_lshl_b32 s73, s56, 10
    s_add_u32 s72, s72, s73
    s_add_u32 s72, s72, 0xd00000
    s_mul_i32 s84, s57, 40960
    s_add_u32 s73, s73, s84
    s_add_u32 s73, s73, 0xf00000
    s_cmp_eq_u32 s58, 1
    s_cbranch_scc1 L_uB_6
    s_cmp_eq_u32 s58, 2
    s_cbranch_scc1 L_uC_7
    s_add_u32 s74, s70, 0
    s_add_u32 s75, s70, 96
    s_add_u32 s76, s70, 128
    s_add_u32 s77, s70, 64
    s_add_u32 s78, s72, 0
    s_add_u32 s79, s72, 20480
    s_add_u32 s80, s72, 61440
    s_add_u32 s81, s72, 81920
    s_add_u32 s82, s72, 40960
    s_mov_b32 s84, 2
    s_branch L_up_5
L_uB_6:
    s_add_u32 s74, s70, 192
    s_add_u32 s75, s70, 160
    s_add_u32 s76, s70, 256
    s_mov_b32 s77, s71
    s_add_u32 s78, s72, 122880
    s_add_u32 s79, s72, 143360
    s_add_u32 s80, s72, 102400
    s_add_u32 s81, s72, 163840
    s_mov_b32 s82, s73
    s_mov_b32 s84, 3
    s_branch L_up_5
L_uC_7:
    s_add_u32 s74, s70, 288
    s_add_u32 s75, s70, 352
    s_add_u32 s76, s71, 32
    s_mov_b32 s77, 0x80000000
    s_add_u32 s78, s72, 184320
    s_add_u32 s79, s72, 204800
    s_add_u32 s80, s72, 225280
    s_add_u32 s81, s73, 20480
    s_mov_b32 s82, 0x80000000
    s_mov_b32 s84, 3
    s_branch L_up_5
L_u4_4:
    s_sub_u32 s70, s56, 20
    s_lshl_b32 s70, s70, 2
    s_add_u32 s70, s70, s58
    s_add_u32 s70, s70, 20
    s_cmp_lt_u32 s56, 20
    s_cselect_b32 s70, s56, s70
    s_mov_b32 s91, 1280
    s_mul_i32 s83, s70, 40960
    s_mul_i32 s71, s57, 160
    s_add_u32 s74, s71, 0
    s_add_u32 s75, s71, 64
    s_add_u32 s76, s71, 96
    s_add_u32 s77, s71, 128
    s_mul_i32 s72, s57, 286720
    s_mul_i32 s73, s70, 5120
    s_add_u32 s72, s72, s73
    s_add_u32 s72, s72, 0x1000000
    s_cmp_lt_u32 s70, 54
    s_cselect_b32 s72, s72, 0x80000000
    s_cselect_b32 s83, s83, 0x80000000
    s_add_u32 s78, s72, 0
    s_add_u32 s79, s72, 1024
    s_add_u32 s80, s72, 2048
    s_add_u32 s81, s72, 3072
    s_add_u32 s82, s72, 4096
    s_mov_b32 s84, 0
L_up_5:
    s_cmp_lg_u32 s84, 0
    s_cselect_b32 s52, s24, s28
    s_cselect_b32 s53, s25, s29
    s_mov_b32 s54, 2211840
    s_mov_b32 s55, 0x20000
    v_and_b32 v10, 1, v173
    v_lshlrev_b32 v10, 4, v10
    v_lshl_add_u32 v9, v173, 4, s74
    v_cmp_le_u32 vcc, 4, v173
    v_add_u32 v11, s75, v10
    s_nop 0
    v_cndmask_b32 v9, v9, v11, vcc
    v_cmp_le_u32 vcc, 6, v173
    v_add_u32 v11, s76, v10
    s_nop 0
    v_cndmask_b32 v9, v9, v11, vcc
    v_cmp_le_u32 vcc, 8, v173
    v_add_u32 v11, s77, v10
    s_nop 0
    v_cndmask_b32 v9, v9, v11, vcc
    v_mad_u32_u24 v245, v168, s91, v9
    v_and_b32 v10, 1, v174
    v_lshlrev_b32 v10, 4, v10
    v_lshl_add_u32 v9, v174, 4, s74
    v_cmp_le_u32 vcc, 4, v174
    v_add_u32 v11, s75, v10
    s_nop 0
    v_cndmask_b32 v9, v9, v11, vcc
    v_cmp_le_u32 vcc, 6, v174
    v_add_u32 v11, s76, v10
    s_nop 0
    v_cndmask_b32 v9, v9, v11, vcc
    v_cmp_le_u32 vcc, 8, v174
    v_add_u32 v11, s77, v10
    s_nop 0
    v_cndmask_b32 v9, v9, v11, vcc
    v_mad_u32_u24 v246, v169, s91, v9
    v_and_b32 v10, 1, v175
    v_lshlrev_b32 v10, 4, v10
    v_lshl_add_u32 v9, v175, 4, s74
    v_cmp_le_u32 vcc, 4, v175
    v_add_u32 v11, s75, v10
    s_nop 0
    v_cndmask_b32 v9, v9, v11, vcc
    v_cmp_le_u32 vcc, 6, v175
    v_add_u32 v11, s76, v10
    s_nop 0
    v_cndmask_b32 v9, v9, v11, vcc
    v_cmp_le_u32 vcc, 8, v175
    v_add_u32 v11, s77, v10
    s_nop 0
    v_cndmask_b32 v9, v9, v11, vcc
    v_mad_u32_u24 v247, v170, s91, v9
    v_and_b32 v10, 1, v176
    v_lshlrev_b32 v10, 4, v10
    v_lshl_add_u32 v9, v176, 4, s74
    v_cmp_le_u32 vcc, 4, v176
    v_add_u32 v11, s75, v10
    s_nop 0
    v_cndmask_b32 v9, v9, v11, vcc
    v_cmp_le_u32 vcc, 6, v176
    v_add_u32 v11, s76, v10
    s_nop 0
    v_cndmask_b32 v9, v9, v11, vcc
    v_cmp_le_u32 vcc, 8, v176
    v_add_u32 v11, s77, v10
    s_nop 0
    v_cndmask_b32 v9, v9, v11, vcc
    v_mad_u32_u24 v248, v171, s91, v9
    v_and_b32 v10, 1, v177
    v_lshlrev_b32 v10, 4, v10
    v_lshl_add_u32 v9, v177, 4, s74
    v_cmp_le_u32 vcc, 4, v177
    v_add_u32 v11, s75, v10
    s_nop 0
    v_cndmask_b32 v9, v9, v11, vcc
    v_cmp_le_u32 vcc, 6, v177
    v_add_u32 v11, s76, v10
    s_nop 0
    v_cndmask_b32 v9, v9, v11, vcc
    v_cmp_le_u32 vcc, 8, v177
    v_add_u32 v11, s77, v10
    s_nop 0
    v_cndmask_b32 v9, v9, v11, vcc
    v_mad_u32_u24 v249, v172, s91, v9
    v_mul_u32_u24 v9, 11, v2
    v_lshrrev_b32 v9, 5, v9
    v_mul_u32_u24 v9, 3712, v9
    s_lshl_b32 s70, s56, 7
    s_add_u32 s70, s70, 0x1cfff80
    v_add_u32 v9, s70, v9
    v_lshrrev_b32 v10, 2, v2
    v_mul_u32_u24 v10, 7680, v10
    s_lshl_b32 s70, s57, 9
    s_add_u32 s70, s70, 0x1d04000
    v_add_u32 v10, s70, v10
    v_cmp_eq_u32 vcc, 1, v3
    s_lshl_b32 s70, s57, 11
    s_add_u32 s70, s70, 0x1d08000
    v_cndmask_b32 v9, v9, v10, vcc
    v_mov_b32 v10, s70
    v_cmp_eq_u32 vcc, 2, v3
    s_nop 1
    v_cndmask_b32 v9, v9, v10, vcc
    v_lshl_add_u32 v46, v2, 7, v9
    s_cmp_lg_u32 s58, 2
    s_cbranch_scc1 L_ntf_8
    s_mov_b32 exec_lo, 0x00ff01ff
    s_mov_b32 exec_hi, 0x3ff
    buffer_load_dword v0, v46, s[36:39], 0 offen
    s_mov_b64 exec, -1
L_ntf_8:
    s_add_u32 m0, s92, 4096
    s_nop 0
    buffer_load_dwordx4 v244, s[16:19], s95 offen lds
    s_add_u32 s95, s3, 1
    s_and_b32 s95, s95, 3
    s_mul_i32 s95, s95, 40960
    s_add_u32 s95, s95, s85
    s_add_u32 m0, s92, 5120
    s_nop 0
    buffer_load_dwordx4 v240, s[16:19], s95 offen lds
    s_add_u32 m0, s92, 6144
    s_nop 0
    buffer_load_dwordx4 v241, s[16:19], s95 offen lds
    s_add_u32 m0, s92, 7168
    s_nop 0
    buffer_load_dwordx4 v242, s[16:19], s95 offen lds
    v_mul_u32_u24 v10, 1280, v2
    s_mul_i32 s70, s58, 20
    s_add_u32 s71, s3, 0
    s_and_b32 s71, s71, 3
    s_lshl_b32 s71, s71, 2
    s_add_u32 s71, s71, s70
    v_add_u32 v9, s71, v3
    v_xor_b32 v9, v9, v2
    v_lshl_add_u32 v160, v9, 4, v10
    s_add_u32 s71, s3, 1
    s_and_b32 s71, s71, 3
    s_lshl_b32 s71, s71, 2
    s_add_u32 s71, s71, s70
    v_add_u32 v9, s71, v3
    v_xor_b32 v9, v9, v2
    v_lshl_add_u32 v161, v9, 4, v10
    s_add_u32 s71, s3, 2
    s_and_b32 s71, s71, 3
    s_lshl_b32 s71, s71, 2
    s_add_u32 s71, s71, s70
    v_add_u32 v9, s71, v3
    v_xor_b32 v9, v9, v2
    v_lshl_add_u32 v162, v9, 4, v10
    s_add_u32 s71, s3, 3
    s_and_b32 s71, s71, 3
    s_lshl_b32 s71, s71, 2
    s_add_u32 s71, s71, s70
    v_add_u32 v9, s71, v3
    v_xor_b32 v9, v9, v2
    v_lshl_add_u32 v163, v9, 4, v10
    v_add3_u32 v9, v3, 16, s70
    v_xor_b32 v9, v9, v2
    v_lshl_add_u32 v164, v9, 4, v10
    s_mul_i32 s70, s57, 10
    v_add_u32 v10, s86, v10
    v_add3_u32 v9, v3, 0, s70
    s_add_u32 m0, s92, 8192
    s_nop 0
    buffer_load_dwordx4 v243, s[16:19], s95 offen lds
    v_xor_b32 v9, v9, v2
    v_lshl_add_u32 v165, v9, 4, v10
    v_add3_u32 v9, v3, 4, s70
    v_xor_b32 v9, v9, v2
    v_lshl_add_u32 v166, v9, 4, v10
    v_lshrrev_b32 v9, 1, v3
    v_add3_u32 v9, v9, 8, s70
    v_xor_b32 v9, v9, v2
    v_lshl_add_u32 v167, v9, 4, v10
    v_and_b32 v9, 1, v3
    v_lshl_add_u32 v167, v9, 3, v167
    v_mov_b32 v9, 0x3f803f80
    v_accvgpr_write_b32 a152, v9
    v_accvgpr_write_b32 a153, v9
    v_accvgpr_write_b32 a154, v9
    v_accvgpr_write_b32 a155, v9
    s_mul_i32 s70, s66, 20480
    s_mul_i32 s71, s67, 20480
    s_mul_i32 s72, s68, 20480
    s_mul_i32 s73, s69, 20480
    s_waitcnt vmcnt(9)
    s_barrier
    v_add_u32 v9, s70, v160
    s_add_u32 m0, s92, 9216
    s_nop 0
    buffer_load_dwordx4 v244, s[16:19], s95 offen lds
    ds_read_b128 v[80:83], v9
    v_add_u32 v10, s70, v161
    ds_read_b128 v[84:87], v10
    v_add_u32 v9, s70, v162
    ds_read_b128 v[88:91], v9
    v_add_u32 v10, s70, v163
    ds_read_b128 v[92:95], v10
    v_add_u32 v9, s70, v164
    ds_read_b128 v[96:99], v9
    v_add_u32 v9, s71, v160
    ds_read_b128 v[100:103], v9
    v_add_u32 v10, s71, v161
    ds_read_b128 v[104:107], v10
    v_add_u32 v9, s71, v162
    ds_read_b128 v[108:111], v9
    v_add_u32 v10, s71, v163
    ds_read_b128 v[112:115], v10
    v_add_u32 v9, s71, v164
    s_add_u32 s95, s3, 2
    s_and_b32 s95, s95, 3
    s_mul_i32 s95, s95, 40960
    s_add_u32 s95, s95, s85
    s_add_u32 m0, s92, 10240
    s_nop 0
    buffer_load_dwordx4 v240, s[16:19], s95 offen lds
    ds_read_b128 v[116:119], v9
    v_add_u32 v9, s72, v160
    ds_read_b128 v[120:123], v9
    v_add_u32 v10, s72, v161
    ds_read_b128 v[124:127], v10
    v_add_u32 v9, s72, v162
    ds_read_b128 v[128:131], v9
    v_add_u32 v10, s72, v163
    ds_read_b128 v[132:135], v10
    v_add_u32 v9, s72, v164
    ds_read_b128 v[136:139], v9
    v_add_u32 v9, s73, v160
    ds_read_b128 v[140:143], v9
    v_add_u32 v10, s73, v161
    ds_read_b128 v[144:147], v10
    v_add_u32 v9, s73, v162
    ds_read_b128 v[148:151], v9
    s_add_u32 m0, s92, 11264
    s_nop 0
    buffer_load_dwordx4 v241, s[16:19], s95 offen lds
    v_add_u32 v10, s73, v163
    ds_read_b128 v[152:155], v10
    v_add_u32 v9, s73, v164
    ds_read_b128 v[156:159], v9
    ds_read_b128 v[24:27], v165
    ds_read_b128 v[28:31], v166
    ds_read_b64 v[32:33], v167
    s_waitcnt lgkmcnt(15)
    v_mfma_f32_16x16x32_bf16 a[100:103], a[152:155], v[80:83], 0
    v_lshrrev_b32 v11, 2, v1
    v_mul_u32_u24 v11, 160, v11
    v_mfma_f32_16x16x32_bf16 a[104:107], v[80:83], v[80:83], 0
    v_and_b32 v12, 3, v1
    v_lshl_add_u32 v250, v12, 4, v11
    v_mfma_f32_16x16x32_bf16 a[100:103], a[152:155], v[84:87], a[100:103]
    v_lshl_add_u32 v251, v12, 3, v11
    v_add_u32 v252, s92, v250
    s_add_u32 m0, s92, 12288
    s_nop 0
    buffer_load_dwordx4 v242, s[16:19], s95 offen lds
    v_mfma_f32_16x16x32_bf16 a[104:107], v[84:87], v[84:87], a[104:107]
    v_add_u32 v253, s92, v251
    v_add_u32 v250, s61, v250
    v_mfma_f32_16x16x32_bf16 a[100:103], a[152:155], v[88:91], a[100:103]
    v_add_u32 v251, s61, v251
    s_nop 0
    v_mfma_f32_16x16x32_bf16 a[104:107], v[88:91], v[88:91], a[104:107]
    v_cmp_le_u32 vcc, 20, v1
    s_nop 1
    v_cndmask_b32 v11, 0, 1, vcc
    v_mfma_f32_16x16x32_bf16 a[100:103], a[152:155], v[92:95], a[100:103]
    v_mul_u32_u24 v12, 20, v11
    v_sub_u32 v12, v1, v12
    s_add_u32 m0, s92, 13312
    s_nop 0
    buffer_load_dwordx4 v243, s[16:19], s95 offen lds
    v_mfma_f32_16x16x32_bf16 a[104:107], v[92:95], v[92:95], a[104:107]
    v_cmp_le_u32 vcc, 10, v12
    s_nop 1
    v_cndmask_b32 v13, 0, 1, vcc
    v_mfma_f32_16x16x32_bf16 a[100:103], a[152:155], v[96:99], a[100:103]
    v_mul_u32_u24 v14, 10, v13
    v_sub_u32 v14, v12, v14
    v_mfma_f32_16x16x32_bf16 a[104:107], v[96:99], v[96:99], a[104:107]
    v_mul_u32_u24 v254, 15360, v13
    v_lshl_add_u32 v254, v14, 9, v254
    v_mfma_f32_16x16x32_bf16 a[108:111], a[152:155], v[100:103], 0
    s_lshl_b32 s74, s58, 1
    s_sub_u32 s74, 7, s74
    v_mfma_f32_16x16x32_bf16 a[112:115], v[100:103], v[100:103], 0
    v_sub_u32 v13, s74, v11
    v_and_b32 v14, 7, v14
    s_add_u32 m0, s92, 14336
    s_nop 0
    buffer_load_dwordx4 v244, s[16:19], s95 offen lds
    v_mfma_f32_16x16x32_bf16 a[108:111], a[152:155], v[104:107], a[108:111]
    v_xor_b32 v13, v13, v14
    v_lshl_add_u32 v254, v13, 4, v254
    v_mfma_f32_16x16x32_bf16 a[112:115], v[104:107], v[104:107], a[112:115]
    v_add_u32 v254, 5120, v254
    v_mul_u32_u24 v11, 1280, v11
    v_mfma_f32_16x16x32_bf16 a[108:111], a[152:155], v[108:111], a[108:111]
    v_lshl_add_u32 v11, v12, 3, v11
    s_add_u32 s74, s61, 5760
    v_mfma_f32_16x16x32_bf16 a[112:115], v[108:111], v[108:111], a[112:115]
    v_add_u32 v255, s74, v11
    s_mul_i32 s74, s57, 80
    s_add_u32 s95, s3, 3
    s_and_b32 s95, s95, 3
    s_mul_i32 s95, s95, 40960
    s_add_u32 s95, s95, s85
    s_add_u32 m0, s92, 15360
    s_nop 0
    buffer_load_dwordx4 v240, s[16:19], s95 offen lds
    s_waitcnt lgkmcnt(14)
    v_mfma_f32_16x16x32_bf16 a[108:111], a[152:155], v[112:115], a[108:111]
    v_lshl_add_u32 v12, v12, 2, s74
    v_lshlrev_b32 v12, 3, v12
    v_mfma_f32_16x16x32_bf16 a[112:115], v[112:115], v[112:115], a[112:115]
    v_cmp_gt_u32 vcc, 40, v1
    s_sub_u32 s74, s96, 4
    s_waitcnt lgkmcnt(13)
    v_mfma_f32_16x16x32_bf16 a[108:111], a[152:155], v[116:119], a[108:111]
    s_mul_i32 s74, s74, 1280
    v_cndmask_b32 v47, -2.0, v12, vcc
    v_mfma_f32_16x16x32_bf16 a[112:115], v[116:119], v[116:119], a[112:115]
    s_mul_i32 s75, s57, 160
    s_add_u32 s74, s74, s75
    s_add_u32 m0, s92, 16384
    s_nop 0
    buffer_load_dwordx4 v241, s[16:19], s95 offen lds
    s_waitcnt lgkmcnt(0)
    s_barrier
    v_add_u32 v72, s74, v72
    v_add_u32 v73, s74, v73
    v_add_u32 v74, s74, v74
    v_add_u32 v75, s74, v75
    s_nop 0
    s_waitcnt vmcnt(12)
    ds_read_b64_tr_b16 a[0:1], v252 offset:0
    ds_read_b64_tr_b16 a[2:3], v252 offset:2560
    ds_read_b64_tr_b16 a[4:5], v252 offset:8
    ds_read_b64_tr_b16 a[6:7], v252 offset:2568
    ds_read_b64_tr_b16 a[8:9], v252 offset:64
    ds_read_b64_tr_b16 a[10:11], v252 offset:2624
    ds_read_b64_tr_b16 a[12:13], v252 offset:72
    ds_read_b64_tr_b16 a[14:15], v252 offset:2632
    ds_read_b64_tr_b16 a[16:17], v253 offset:128
    ds_read_b64_tr_b16 a[18:19], v253 offset:2688
    v_mfma_f32_16x16x32_bf16 a[116:119], a[152:155], v[120:123], 0
    s_add_u32 m0, s92, 17408
    s_nop 0
    buffer_load_dwordx4 v242, s[16:19], s95 offen lds
    v_mfma_f32_16x16x32_bf16 a[120:123], v[120:123], v[120:123], 0
    v_mfma_f32_16x16x32_bf16 a[116:119], a[152:155], v[124:127], a[116:119]
    v_mfma_f32_16x16x32_bf16 a[120:123], v[124:127], v[124:127], a[120:123]
    v_mfma_f32_16x16x32_bf16 a[116:119], a[152:155], v[128:131], a[116:119]
    s_add_u32 m0, s92, 18432
    s_nop 0
    buffer_load_dwordx4 v243, s[16:19], s95 offen lds
    v_mfma_f32_16x16x32_bf16 a[120:123], v[128:131], v[128:131], a[120:123]
    v_mfma_f32_16x16x32_bf16 a[116:119], a[152:155], v[132:135], a[116:119]
    v_mfma_f32_16x16x32_bf16 a[120:123], v[132:135], v[132:135], a[120:123]
    v_mfma_f32_16x16x32_bf16 a[116:119], a[152:155], v[136:139], a[116:119]
    v_mfma_f32_16x16x32_bf16 a[120:123], v[136:139], v[136:139], a[120:123]
    s_add_u32 m0, s92, 19456
    s_nop 0
    buffer_load_dwordx4 v244, s[16:19], s95 offen lds
    v_mfma_f32_16x16x32_bf16 a[124:127], a[152:155], v[140:143], 0
    v_mfma_f32_16x16x32_bf16 a[128:131], v[140:143], v[140:143], 0
    v_mfma_f32_16x16x32_bf16 a[124:127], a[152:155], v[144:147], a[124:127]
    v_mfma_f32_16x16x32_bf16 a[128:131], v[144:147], v[144:147], a[128:131]
    v_mfma_f32_16x16x32_bf16 a[124:127], a[152:155], v[148:151], a[124:127]
    s_add_u32 m0, s61, 5760
    s_nop 0
    buffer_load_dwordx4 v72, s[8:11], 0 offen nt lds
    v_mfma_f32_16x16x32_bf16 a[128:131], v[148:151], v[148:151], a[128:131]
    v_mfma_f32_16x16x32_bf16 a[124:127], a[152:155], v[152:155], a[124:127]
    v_mfma_f32_16x16x32_bf16 a[128:131], v[152:155], v[152:155], a[128:131]
    v_mfma_f32_16x16x32_bf16 a[124:127], a[152:155], v[156:159], a[124:127]
    s_add_u32 m0, s61, 6784
    s_nop 0
    buffer_load_dwordx4 v73, s[8:11], 0 offen nt lds
    v_mfma_f32_16x16x32_bf16 a[128:131], v[156:159], v[156:159], a[128:131]
    s_waitcnt lgkmcnt(0)
    v_mfma_f32_16x16x32_bf16 a[132:135], a[0:3], a[152:155], 0
    v_mfma_f32_16x16x32_bf16 a[136:139], a[4:7], a[152:155], 0
    v_mfma_f32_16x16x32_bf16 a[140:143], a[8:11], a[152:155], 0
    s_mov_b32 s70, 0x22222222
    v_mfma_f32_16x16x32_bf16 a[144:147], a[12:15], a[152:155], 0
    s_mov_b32 s71, 0x22222222
    s_mov_b32 s72, 0x44444444
    v_mfma_f32_16x16x32_bf16 a[148:151], a[16:19], a[152:155], 0
    s_mov_b32 s73, 0x44444444
    s_mov_b32 s74, 0x88888888
    s_add_u32 m0, s61, 7808
    s_nop 0
    buffer_load_dwordx4 v74, s[8:11], 0 offen nt lds
    v_mfma_f32_16x16x32_bf16 v[160:163], a[0:3], v[80:83], 0
    s_mov_b32 s75, 0x88888888
    s_add_u32 s76, s61, 5120
    v_mfma_f32_16x16x32_bf16 v[164:167], a[4:7], v[80:83], 0
    v_lshl_add_u32 v15, v2, 3, s76
    v_accvgpr_read_b32 v11, a104
    v_mfma_f32_16x16x32_bf16 v[168:171], a[8:11], v[80:83], 0
    v_accvgpr_read_b32 v12, a105
    v_accvgpr_read_b32 v13, a106
    v_mfma_f32_16x16x32_bf16 v[172:175], a[12:15], v[80:83], 0
    v_accvgpr_read_b32 v14, a107
    v_accvgpr_read_b32 v10, a100
    v_mfma_f32_16x16x32_bf16 v[176:179], a[16:19], v[80:83], 0
    v_cndmask_b32 v11, v11, v12, s[70:71]
    v_cndmask_b32 v11, v11, v13, s[72:73]
    s_add_u32 m0, s61, 8832
    s_mov_b64 exec, 0xff
    buffer_load_dwordx4 v75, s[8:11], 0 offen nt lds
    s_mov_b64 exec, -1
    v_mfma_f32_16x16x32_bf16 v[180:183], a[0:3], v[100:103], 0
    v_cndmask_b32 v11, v11, v14, s[74:75]
    s_lshl_b32 s76, s66, 7
    v_mfma_f32_16x16x32_bf16 v[184:187], a[4:7], v[100:103], 0
    v_add_u32 v16, s76, v15
    s_mov_b32 exec_lo, 0x00f0000f
    s_mov_b32 exec_hi, 0xf0000f00
    ds_write_b64 v16, v[10:11]
    s_mov_b64 exec, -1
    v_mfma_f32_16x16x32_bf16 v[188:191], a[8:11], v[100:103], 0
    v_mfma_f32_16x16x32_bf16 v[192:195], a[12:15], v[100:103], 0
    v_accvgpr_read_b32 v11, a112
    s_add_u32 m0, s61, 8960
    v_add_u32 v72, 3840, v72
    buffer_load_dwordx4 v72, s[12:15], 0 offen nt lds
    v_mfma_f32_16x16x32_bf16 v[196:199], a[16:19], v[100:103], 0
    v_accvgpr_read_b32 v12, a113
    v_accvgpr_read_b32 v13, a114
    s_waitcnt vmcnt(15)
    v_mfma_f32_16x16x32_bf16 v[200:203], a[0:3], v[120:123], 0
    v_accvgpr_read_b32 v14, a115
    ds_read_b64_tr_b16 a[20:21], v252 offset:5120
    v_mfma_f32_16x16x32_bf16 v[204:207], a[4:7], v[120:123], 0
    v_accvgpr_read_b32 v10, a108
    ds_read_b64_tr_b16 a[22:23], v252 offset:7680
    v_mfma_f32_16x16x32_bf16 v[208:211], a[8:11], v[120:123], 0
    v_cndmask_b32 v11, v11, v12, s[70:71]
    ds_read_b64_tr_b16 a[24:25], v252 offset:5128
    v_mfma_f32_16x16x32_bf16 v[212:215], a[12:15], v[120:123], 0
    v_cndmask_b32 v11, v11, v13, s[72:73]
    s_add_u32 m0, s61, 9984
    v_add_u32 v73, 3840, v73
    buffer_load_dwordx4 v73, s[12:15], 0 offen nt lds
    ds_read_b64_tr_b16 a[26:27], v252 offset:7688
    v_mfma_f32_16x16x32_bf16 v[216:219], a[16:19], v[120:123], 0
    v_cndmask_b32 v11, v11, v14, s[74:75]
    ds_read_b64_tr_b16 a[28:29], v252 offset:5184
    v_mfma_f32_16x16x32_bf16 v[220:223], a[0:3], v[140:143], 0
    s_lshl_b32 s76, s67, 7
    ds_read_b64_tr_b16 a[30:31], v252 offset:7744
    v_mfma_f32_16x16x32_bf16 v[224:227], a[4:7], v[140:143], 0
    v_add_u32 v16, s76, v15
    ds_read_b64_tr_b16 a[32:33], v252 offset:5192
    v_mfma_f32_16x16x32_bf16 v[228:231], a[8:11], v[140:143], 0
    s_mov_b32 exec_lo, 0x00f0000f
    s_mov_b32 exec_hi, 0xf0000f00
    ds_write_b64 v16, v[10:11]
    s_mov_b64 exec, -1
    ds_read_b64_tr_b16 a[34:35], v252 offset:7752
    s_add_u32 m0, s61, 11008
    v_add_u32 v74, 3840, v74
    s_mov_b32 exec_hi, 0x3ff
    buffer_load_dwordx4 v74, s[12:15], 0 offen nt lds
    s_mov_b32 exec_hi, -1
    v_mfma_f32_16x16x32_bf16 v[232:235], a[12:15], v[140:143], 0
    ds_read_b64_tr_b16 a[36:37], v253 offset:5248
    v_mfma_f32_16x16x32_bf16 v[236:239], a[16:19], v[140:143], 0
    ds_read_b64_tr_b16 a[38:39], v253 offset:7808
    v_accvgpr_read_b32 v11, a120
    v_accvgpr_read_b32 v12, a121
    v_accvgpr_read_b32 v13, a122
    v_accvgpr_read_b32 v14, a123
    v_accvgpr_read_b32 v10, a116
    v_cndmask_b32 v11, v11, v12, s[70:71]
    v_cndmask_b32 v11, v11, v13, s[72:73]
    v_cndmask_b32 v11, v11, v14, s[74:75]
    s_lshl_b32 s76, s68, 7
    v_add_u32 v16, s76, v15
    s_mov_b32 exec_lo, 0x00f0000f
    s_mov_b32 exec_hi, 0xf0000f00
    ds_write_b64 v16, v[10:11]
    s_mov_b64 exec, -1
    v_accvgpr_read_b32 v11, a128
    v_accvgpr_read_b32 v12, a129
    v_accvgpr_read_b32 v13, a130
    v_accvgpr_read_b32 v14, a131
    v_accvgpr_read_b32 v10, a124
    v_cndmask_b32 v11, v11, v12, s[70:71]
    v_cndmask_b32 v11, v11, v13, s[72:73]
    v_cndmask_b32 v11, v11, v14, s[74:75]
    s_lshl_b32 s76, s69, 7
    v_add_u32 v16, s76, v15
    s_mov_b32 exec_lo, 0x00f0000f
    s_mov_b32 exec_hi, 0xf0000f00
    ds_write_b64 v16, v[10:11]
    s_mov_b64 exec, -1
    s_nop 0
    s_waitcnt lgkmcnt(0)
    s_barrier
    v_lshlrev_b32 v16, 3, v2
    s_add_u32 s95, s85, 163840
    s_add_u32 m0, s61, 0
    s_nop 0
    buffer_load_dwordx4 v240, s[16:19], s95 offen lds
    s_lshl_b32 s76, s66, 7
    s_add_u32 s76, s76, 5120
    v_add_u32 v15, s76, v16
    s_add_u32 m0, s61, 1024
    s_nop 0
    buffer_load_dwordx4 v241, s[16:19], s95 offen lds
    ds_read_b64 a[100:101], v15 offset:0
    ds_read_b64 a[102:103], v15 offset:15360
    ds_read_b64 a[104:105], v15 offset:30720
    ds_read_b64 a[106:107], v15 offset:46080
    s_lshl_b32 s76, s67, 7
    s_add_u32 s76, s76, 5120
    v_add_u32 v15, s76, v16
    ds_read_b64 a[108:109], v15 offset:0
    ds_read_b64 a[110:111], v15 offset:15360
    ds_read_b64 a[112:113], v15 offset:30720
    ds_read_b64 a[114:115], v15 offset:46080
    s_lshl_b32 s76, s68, 7
    s_add_u32 s76, s76, 5120
    v_add_u32 v15, s76, v16
    ds_read_b64 a[116:117], v15 offset:0
    ds_read_b64 a[118:119], v15 offset:15360
    ds_read_b64 a[120:121], v15 offset:30720
    ds_read_b64 a[122:123], v15 offset:46080
    s_add_u32 m0, s61, 2048
    s_nop 0
    buffer_load_dwordx4 v242, s[16:19], s95 offen lds
    s_lshl_b32 s76, s69, 7
    s_add_u32 s76, s76, 5120
    v_add_u32 v15, s76, v16
    ds_read_b64 a[124:125], v15 offset:0
    ds_read_b64 a[126:127], v15 offset:15360
    ds_read_b64 a[128:129], v15 offset:30720
    ds_read_b64 a[130:131], v15 offset:46080
    s_waitcnt lgkmcnt(0)
    v_mfma_f32_16x16x32_bf16 a[132:135], a[20:23], a[152:155], a[132:135]
    v_mfma_f32_16x16x32_bf16 a[136:139], a[24:27], a[152:155], a[136:139]
    v_mfma_f32_16x16x32_bf16 a[140:143], a[28:31], a[152:155], a[140:143]
    v_mfma_f32_16x16x32_bf16 a[144:147], a[32:35], a[152:155], a[144:147]
    s_add_u32 m0, s61, 3072
    s_nop 0
    buffer_load_dwordx4 v243, s[16:19], s95 offen lds
    v_mfma_f32_16x16x32_bf16 a[148:151], a[36:39], a[152:155], a[148:151]
    v_mfma_f32_16x16x32_bf16 v[160:163], a[20:23], v[84:87], v[160:163]
    v_mfma_f32_16x16x32_bf16 v[164:167], a[24:27], v[84:87], v[164:167]
    v_mfma_f32_16x16x32_bf16 v[168:171], a[28:31], v[84:87], v[168:171]
    s_add_u32 m0, s61, 4096
    s_nop 0
    buffer_load_dwordx4 v244, s[16:19], s95 offen lds
    v_mfma_f32_16x16x32_bf16 v[172:175], a[32:35], v[84:87], v[172:175]
    v_mov_b32 v18, 0
    buffer_load_dwordx2 v[18:19], v18, s[48:51], 0 offen sc1
    v_mfma_f32_16x16x32_bf16 v[176:179], a[36:39], v[84:87], v[176:179]
    v_mfma_f32_16x16x32_bf16 v[180:183], a[20:23], v[104:107], v[180:183]
    buffer_load_dwordx4 a[156:159], v47, s[44:47], 0 offen offset:0
    v_mfma_f32_16x16x32_bf16 v[184:187], a[24:27], v[104:107], v[184:187]
    v_mfma_f32_16x16x32_bf16 v[188:191], a[28:31], v[104:107], v[188:191]
    buffer_load_dwordx4 a[160:163], v47, s[44:47], 0 offen offset:16
    v_mfma_f32_16x16x32_bf16 v[192:195], a[32:35], v[104:107], v[192:195]
    v_mfma_f32_16x16x32_bf16 v[196:199], a[36:39], v[104:107], v[196:199]
    s_waitcnt vmcnt(20)
    v_mfma_f32_16x16x32_bf16 v[200:203], a[20:23], v[124:127], v[200:203]
    ds_read_b64_tr_b16 a[40:41], v252 offset:10240
    v_mfma_f32_16x16x32_bf16 v[204:207], a[24:27], v[124:127], v[204:207]
    s_add_u32 s95, s3, 0
    s_and_b32 s95, s95, 3
    s_mul_i32 s95, s95, 40960
    s_add_u32 s95, s95, s85
    s_add_u32 m0, s92, 0
    s_nop 0
    buffer_load_dwordx4 v240, s[20:23], s95 offen lds
    ds_read_b64_tr_b16 a[42:43], v252 offset:12800
    v_mfma_f32_16x16x32_bf16 v[208:211], a[28:31], v[124:127], v[208:211]
    ds_read_b64_tr_b16 a[44:45], v252 offset:10248
    v_mfma_f32_16x16x32_bf16 v[212:215], a[32:35], v[124:127], v[212:215]
    ds_read_b64_tr_b16 a[46:47], v252 offset:12808
    v_mfma_f32_16x16x32_bf16 v[216:219], a[36:39], v[124:127], v[216:219]
    ds_read_b64_tr_b16 a[48:49], v252 offset:10304
    v_mfma_f32_16x16x32_bf16 v[220:223], a[20:23], v[144:147], v[220:223]
    ds_read_b64_tr_b16 a[50:51], v252 offset:12864
    v_mfma_f32_16x16x32_bf16 v[224:227], a[24:27], v[144:147], v[224:227]
    s_add_u32 m0, s92, 1024
    s_nop 0
    buffer_load_dwordx4 v241, s[20:23], s95 offen lds
    ds_read_b64_tr_b16 a[52:53], v252 offset:10312
    v_mfma_f32_16x16x32_bf16 v[228:231], a[28:31], v[144:147], v[228:231]
    ds_read_b64_tr_b16 a[54:55], v252 offset:12872
    v_mfma_f32_16x16x32_bf16 v[232:235], a[32:35], v[144:147], v[232:235]
    ds_read_b64_tr_b16 a[56:57], v253 offset:10368
    v_mfma_f32_16x16x32_bf16 v[236:239], a[36:39], v[144:147], v[236:239]
    ds_read_b64_tr_b16 a[58:59], v253 offset:12928
    s_barrier
    s_waitcnt lgkmcnt(0)
    v_mfma_f32_16x16x32_bf16 a[132:135], a[40:43], a[152:155], a[132:135]
    s_add_u32 m0, s92, 2048
    s_nop 0
    buffer_load_dwordx4 v242, s[20:23], s95 offen lds
    v_mfma_f32_16x16x32_bf16 a[136:139], a[44:47], a[152:155], a[136:139]
    v_mfma_f32_16x16x32_bf16 a[140:143], a[48:51], a[152:155], a[140:143]
    v_mfma_f32_16x16x32_bf16 a[144:147], a[52:55], a[152:155], a[144:147]
    v_mfma_f32_16x16x32_bf16 a[148:151], a[56:59], a[152:155], a[148:151]
    v_mfma_f32_16x16x32_bf16 v[160:163], a[40:43], v[88:91], v[160:163]
    s_add_u32 m0, s92, 3072
    s_nop 0
    buffer_load_dwordx4 v243, s[20:23], s95 offen lds
    v_mfma_f32_16x16x32_bf16 v[164:167], a[44:47], v[88:91], v[164:167]
    v_mfma_f32_16x16x32_bf16 v[168:171], a[48:51], v[88:91], v[168:171]
    v_mfma_f32_16x16x32_bf16 v[172:175], a[52:55], v[88:91], v[172:175]
    v_mfma_f32_16x16x32_bf16 v[176:179], a[56:59], v[88:91], v[176:179]
    s_add_u32 m0, s92, 4096
    s_nop 0
    buffer_load_dwordx4 v244, s[20:23], s95 offen lds
    v_mfma_f32_16x16x32_bf16 v[180:183], a[40:43], v[108:111], v[180:183]
    v_mfma_f32_16x16x32_bf16 v[184:187], a[44:47], v[108:111], v[184:187]
    v_mfma_f32_16x16x32_bf16 v[188:191], a[48:51], v[108:111], v[188:191]
    v_mfma_f32_16x16x32_bf16 v[192:195], a[52:55], v[108:111], v[192:195]
    s_add_u32 s95, s3, 1
    s_and_b32 s95, s95, 3
    s_mul_i32 s95, s95, 40960
    s_add_u32 s95, s95, s85
    s_add_u32 m0, s92, 5120
    s_nop 0
    buffer_load_dwordx4 v240, s[20:23], s95 offen lds
    v_mfma_f32_16x16x32_bf16 v[196:199], a[56:59], v[108:111], v[196:199]
    s_waitcnt vmcnt(21)
    v_mfma_f32_16x16x32_bf16 v[200:203], a[40:43], v[128:131], v[200:203]
    s_mov_b32 s76, 0xbacccccd
    ds_read_b64_tr_b16 a[60:61], v252 offset:15360
    v_mfma_f32_16x16x32_bf16 v[204:207], a[44:47], v[128:131], v[204:207]
    s_mov_b32 s77, 0x3727c5ac
    ds_read_b64_tr_b16 a[62:63], v252 offset:17920
    v_mfma_f32_16x16x32_bf16 v[208:211], a[48:51], v[128:131], v[208:211]
    v_accvgpr_read_b32 v11, a100
    ds_read_b64_tr_b16 a[64:65], v252 offset:15368
    v_mfma_f32_16x16x32_bf16 v[212:215], a[52:55], v[128:131], v[212:215]
    v_accvgpr_read_b32 v12, a102
    s_add_u32 m0, s92, 6144
    s_nop 0
    buffer_load_dwordx4 v241, s[20:23], s95 offen lds
    ds_read_b64_tr_b16 a[66:67], v252 offset:17928
    v_mfma_f32_16x16x32_bf16 v[216:219], a[56:59], v[128:131], v[216:219]
    v_accvgpr_read_b32 v13, a104
    ds_read_b64_tr_b16 a[68:69], v252 offset:15424
    v_mfma_f32_16x16x32_bf16 v[220:223], a[40:43], v[148:151], v[220:223]
    v_accvgpr_read_b32 v14, a106
    ds_read_b64_tr_b16 a[70:71], v252 offset:17984
    v_mfma_f32_16x16x32_bf16 v[224:227], a[44:47], v[148:151], v[224:227]
    v_add_f32 v11, v11, v12
    ds_read_b64_tr_b16 a[72:73], v252 offset:15432
    v_mfma_f32_16x16x32_bf16 v[228:231], a[48:51], v[148:151], v[228:231]
    v_add_f32 v13, v13, v14
    s_add_u32 m0, s92, 7168
    s_nop 0
    buffer_load_dwordx4 v242, s[20:23], s95 offen lds
    ds_read_b64_tr_b16 a[74:75], v252 offset:17992
    v_mfma_f32_16x16x32_bf16 v[232:235], a[52:55], v[148:151], v[232:235]
    v_add_f32 v11, v11, v13
    ds_read_b64_tr_b16 a[76:77], v253 offset:15488
    v_mfma_f32_16x16x32_bf16 v[236:239], a[56:59], v[148:151], v[236:239]
    v_mul_f32 v80, s76, v11
    ds_read_b64_tr_b16 a[78:79], v253 offset:18048
    s_waitcnt lgkmcnt(0)
    v_mfma_f32_16x16x32_bf16 a[132:135], a[60:63], a[152:155], a[132:135]
    v_accvgpr_read_b32 v11, a108
    v_accvgpr_read_b32 v12, a110
    v_mfma_f32_16x16x32_bf16 a[136:139], a[64:67], a[152:155], a[136:139]
    v_accvgpr_read_b32 v13, a112
    v_accvgpr_read_b32 v14, a114
    s_add_u32 m0, s92, 8192
    s_nop 0
    buffer_load_dwordx4 v243, s[20:23], s95 offen lds
    v_mfma_f32_16x16x32_bf16 a[140:143], a[68:71], a[152:155], a[140:143]
    v_add_f32 v11, v11, v12
    v_add_f32 v13, v13, v14
    v_mfma_f32_16x16x32_bf16 a[144:147], a[72:75], a[152:155], a[144:147]
    v_add_f32 v11, v11, v13
    v_mul_f32 v81, s76, v11
    v_mfma_f32_16x16x32_bf16 a[148:151], a[76:79], a[152:155], a[148:151]
    v_accvgpr_read_b32 v11, a116
    v_accvgpr_read_b32 v12, a118
    v_mfma_f32_16x16x32_bf16 v[160:163], a[60:63], v[92:95], v[160:163]
    v_accvgpr_read_b32 v13, a120
    v_accvgpr_read_b32 v14, a122
    v_mfma_f32_16x16x32_bf16 v[164:167], a[64:67], v[92:95], v[164:167]
    v_add_f32 v11, v11, v12
    v_add_f32 v13, v13, v14
    s_add_u32 m0, s92, 9216
    s_nop 0
    buffer_load_dwordx4 v244, s[20:23], s95 offen lds
    v_mfma_f32_16x16x32_bf16 v[168:171], a[68:71], v[92:95], v[168:171]
    v_add_f32 v11, v11, v13
    v_mul_f32 v82, s76, v11
    v_mfma_f32_16x16x32_bf16 v[172:175], a[72:75], v[92:95], v[172:175]
    v_accvgpr_read_b32 v11, a124
    v_accvgpr_read_b32 v12, a126
    v_mfma_f32_16x16x32_bf16 v[176:179], a[76:79], v[92:95], v[176:179]
    v_accvgpr_read_b32 v13, a128
    v_accvgpr_read_b32 v14, a130
    v_mfma_f32_16x16x32_bf16 v[180:183], a[60:63], v[112:115], v[180:183]
    v_add_f32 v11, v11, v12
    v_add_f32 v13, v13, v14
    v_mfma_f32_16x16x32_bf16 v[184:187], a[64:67], v[112:115], v[184:187]
    v_add_f32 v11, v11, v13
    v_mul_f32 v83, s76, v11
    s_add_u32 m0, s97, 0
    s_nop 0
    buffer_load_dwordx4 v245, s[52:55], s83 offen nt lds
    v_mfma_f32_16x16x32_bf16 v[188:191], a[68:71], v[112:115], v[188:191]
    v_accvgpr_read_b32 v11, a125
    v_accvgpr_read_b32 v12, a127
    v_mfma_f32_16x16x32_bf16 v[192:195], a[72:75], v[112:115], v[192:195]
    v_accvgpr_read_b32 v13, a129
    v_accvgpr_read_b32 v14, a131
    v_mfma_f32_16x16x32_bf16 v[196:199], a[76:79], v[112:115], v[196:199]
    v_add_f32 v11, v11, v12
    v_add_f32 v13, v13, v14
    s_waitcnt vmcnt(14)
    v_mfma_f32_16x16x32_bf16 v[200:203], a[60:63], v[132:135], v[200:203]
    v_add_f32 v11, v11, v13
    ds_read_b64_tr_b16 a[80:81], v250 offset:0
    v_mfma_f32_16x16x32_bf16 v[204:207], a[64:67], v[132:135], v[204:207]
    v_mul_f32 v11, -s76, v11
    ds_read_b64_tr_b16 a[82:83], v250 offset:2560
    v_mfma_f32_16x16x32_bf16 v[208:211], a[68:71], v[132:135], v[208:211]
    v_fma_f32 v11, -v83, v83, v11
    s_add_u32 m0, s97, 1024
    s_nop 0
    buffer_load_dwordx4 v246, s[52:55], s83 offen nt lds
    ds_read_b64_tr_b16 a[84:85], v250 offset:8
    v_mfma_f32_16x16x32_bf16 v[212:215], a[72:75], v[132:135], v[212:215]
    v_max_f32 v11, 0, v11
    ds_read_b64_tr_b16 a[86:87], v250 offset:2568
    v_mfma_f32_16x16x32_bf16 v[216:219], a[76:79], v[132:135], v[216:219]
    v_add_f32 v44, s77, v11
    ds_read_b64_tr_b16 a[88:89], v250 offset:64
    v_mfma_f32_16x16x32_bf16 v[220:223], a[60:63], v[152:155], v[220:223]
    v_rsq_f32 v44, v44
    ds_read_b64_tr_b16 a[90:91], v250 offset:2624
    v_mfma_f32_16x16x32_bf16 v[224:227], a[64:67], v[152:155], v[224:227]
    v_mul_f32 v12, v44, v44
    ds_read_b64_tr_b16 a[92:93], v250 offset:72
    v_mfma_f32_16x16x32_bf16 v[228:231], a[68:71], v[152:155], v[228:231]
    v_fma_f32 v12, v12, v11, s77
    s_add_u32 m0, s97, 2048
    s_nop 0
    buffer_load_dwordx4 v247, s[52:55], s83 offen nt lds
    ds_read_b64_tr_b16 a[94:95], v250 offset:2632
    v_mfma_f32_16x16x32_bf16 v[232:235], a[72:75], v[152:155], v[232:235]
    v_rsq_f32 v12, v12
    ds_read_b64_tr_b16 a[96:97], v251 offset:128
    v_mfma_f32_16x16x32_bf16 v[236:239], a[76:79], v[152:155], v[236:239]
    v_mul_f32 v45, v83, v44
    ds_read_b64_tr_b16 a[98:99], v251 offset:2688
    s_waitcnt lgkmcnt(0)
    v_mfma_f32_16x16x32_bf16 a[132:135], a[80:83], a[152:155], a[132:135]
    v_mul_f32 v84, v12, v44
    v_mov_b32 v22, 0xc0135761
    v_mfma_f32_16x16x32_bf16 a[136:139], a[84:87], a[152:155], a[136:139]
    s_mov_b32 s94, 0xbdd2d3e8
    v_lshlrev_b32 v46, 4, v2
    v_mfma_f32_16x16x32_bf16 a[140:143], a[88:91], a[152:155], a[140:143]
    v_lshl_add_u32 v46, v3, 15, v46
    s_lshl_b32 s76, s56, 10
    v_mfma_f32_16x16x32_bf16 a[144:147], a[92:95], a[152:155], a[144:147]
    v_add_u32 v46, s76, v46
    s_mul_i32 s76, s57, 327680
    s_add_u32 m0, s97, 3072
    s_nop 0
    buffer_load_dwordx4 v248, s[52:55], s83 offen nt lds
    v_mfma_f32_16x16x32_bf16 a[148:151], a[96:99], a[152:155], a[148:151]
    s_lshl_b32 s77, s69, 8
    s_add_u32 s76, s76, s77
    v_mfma_f32_16x16x32_bf16 v[160:163], a[80:83], v[96:99], v[160:163]
    v_add_u32 v20, s76, v46
    v_lshrrev_b32 v11, 1, v3
    v_mfma_f32_16x16x32_bf16 v[164:167], a[84:87], v[96:99], v[164:167]
    v_sub_u32 v11, v11, v3
    v_lshl_add_u32 v21, v11, 15, v20
    v_mfma_f32_16x16x32_bf16 v[168:171], a[88:91], v[96:99], v[168:171]
    v_and_b32 v11, 1, v3
    v_lshl_add_u32 v21, v11, 3, v21
    v_mfma_f32_16x16x32_bf16 v[172:175], a[92:95], v[96:99], v[172:175]
    s_mov_b32 s30, 131072
    s_mov_b32 s31, 262144
    v_mfma_f32_16x16x32_bf16 v[176:179], a[96:99], v[96:99], v[176:179]
    v_add_u32 v5, s61, v4
    s_mul_i32 s76, s68, 15360
    s_add_u32 m0, s97, 4096
    s_nop 0
    buffer_load_dwordx4 v249, s[52:55], s83 offen nt lds
    v_mfma_f32_16x16x32_bf16 v[180:183], a[80:83], v[116:119], v[180:183]
    s_add_u32 s76, s76, 0
    v_add_u32 v6, s76, v4
    v_mfma_f32_16x16x32_bf16 v[184:187], a[84:87], v[116:119], v[184:187]
    s_mul_i32 s76, s67, 15360
    s_add_u32 s76, s76, 5120
    v_mfma_f32_16x16x32_bf16 v[188:191], a[88:91], v[116:119], v[188:191]
    v_add_u32 v7, s76, v4
    s_mul_i32 s76, s66, 15360
    v_mfma_f32_16x16x32_bf16 v[192:195], a[92:95], v[116:119], v[192:195]
    s_add_u32 s76, s76, 10240
    v_add_u32 v8, s76, v4
    s_add_u32 s95, s3, 2
    s_and_b32 s95, s95, 3
    s_mul_i32 s95, s95, 40960
    s_add_u32 s95, s95, s85
    s_add_u32 m0, s92, 10240
    s_nop 0
    buffer_load_dwordx4 v240, s[20:23], s95 offen lds
    v_mfma_f32_16x16x32_bf16 v[196:199], a[96:99], v[116:119], v[196:199]
    s_lshl_b32 s24, s56, 7
    s_lshl_b32 s76, s57, 3
    v_mfma_f32_16x16x32_bf16 v[200:203], a[80:83], v[136:139], v[200:203]
    s_add_u32 s24, s24, s76
    s_add_u32 s24, s24, 0x1d00000
    v_mfma_f32_16x16x32_bf16 v[204:207], a[84:87], v[136:139], v[204:207]
    s_sub_u32 s76, s92, s97
    v_subrev_u32 v16, s76, v252
    v_mfma_f32_16x16x32_bf16 v[208:211], a[88:91], v[136:139], v[208:211]
    v_subrev_u32 v17, s76, v253
    s_cmp_eq_u32 s84, 3
    s_cselect_b64 vcc, -1, 0
    s_add_u32 m0, s92, 11264
    s_nop 0
    buffer_load_dwordx4 v241, s[20:23], s95 offen lds
    v_mfma_f32_16x16x32_bf16 v[212:215], a[92:95], v[136:139], v[212:215]
    v_add_u32 v14, 64, v16
    v_mfma_f32_16x16x32_bf16 v[216:219], a[96:99], v[136:139], v[216:219]
    v_add_u32 v11, 64, v17
    v_cndmask_b32 v14, v14, v11, vcc
    v_mfma_f32_16x16x32_bf16 v[220:223], a[80:83], v[156:159], v[220:223]
    v_add_u32 v15, 72, v16
    v_add_u32 v11, 96, v17
    v_mfma_f32_16x16x32_bf16 v[224:227], a[84:87], v[156:159], v[224:227]
    v_cndmask_b32 v15, v15, v11, vcc
    s_lshl_b32 s25, s57, 9
    v_mfma_f32_16x16x32_bf16 v[228:231], a[88:91], v[156:159], v[228:231]
    s_lshr_b32 s76, s56, 3
    s_lshl_b32 s76, s76, 7
    s_add_u32 m0, s92, 12288
    s_nop 0
    buffer_load_dwordx4 v242, s[20:23], s95 offen lds
    v_mfma_f32_16x16x32_bf16 v[232:235], a[92:95], v[156:159], v[232:235]
    s_and_b32 s77, s56, 7
    s_lshl_b32 s77, s77, 3
    v_mfma_f32_16x16x32_bf16 v[236:239], a[96:99], v[156:159], v[236:239]
    s_add_u32 s76, s76, s77
    s_add_u32 s25, s25, 0x1d04000
    s_add_u32 s26, s76, s25
    s_lshl_b32 s76, s57, 2
    s_add_u32 s76, s76, s58
    s_mul_i32 s87, s76, 61440
    s_add_u32 s87, s87, 0xd00000
    s_mul_i32 s76, s57, 3
    s_add_u32 s89, s76, s58
    s_and_b32 s91, s89, 1
    s_lshr_b32 s89, s89, 1
    s_lshr_b32 s76, s76, 1
    s_sub_u32 s76, s89, s76
    s_lshl_b32 s77, s57, 1
    s_add_u32 s76, s76, s77
    s_mul_i32 s88, s76, 20480
    s_add_u32 s88, s88, 0xf00000
    s_add_u32 s89, s89, 96
    s_cmp_eq_u32 s58, 3
    s_cselect_b32 s88, 0x80000000, s88
    s_cselect_b32 s91, 0, s91
    s_nop 0
    ds_read_b64 v[48:49], v255 offset:0
    ds_read_b64 v[50:51], v255 offset:160
    ds_read_b64 v[52:53], v255 offset:320
    ds_read_b64 v[54:55], v255 offset:480
    ds_read_b64 v[56:57], v255 offset:640
    ds_read_b64 v[58:59], v255 offset:800
    ds_read_b64 v[60:61], v255 offset:960
    ds_read_b64 v[62:63], v255 offset:1120
    ds_read_b64 v[64:65], v255 offset:1280
    ds_read_b64 v[66:67], v255 offset:1440
    ds_read_b64 v[68:69], v255 offset:1600
    ds_read_b64 v[70:71], v255 offset:1760
    ds_read_b64 v[34:35], v255 offset:3200
    ds_read_b64 v[36:37], v255 offset:3360
    ds_read_b64 v[38:39], v255 offset:3520
    ds_read_b64 v[40:41], v255 offset:3680
    ds_read_b64 v[42:43], v255 offset:3840
    ds_read_b64 v[72:73], v255 offset:4000
    ds_read_b64 v[74:75], v255 offset:4160
    ds_read_b64 v[76:77], v255 offset:4320
    ds_read_b64 v[78:79], v255 offset:4480
    s_waitcnt lgkmcnt(0)
    v_accvgpr_read_b32 v88, a132
    v_accvgpr_read_b32 v89, a133
    v_accvgpr_read_b32 v90, a134
    v_accvgpr_read_b32 v91, a135
    v_accvgpr_read_b32 v92, a136
    v_accvgpr_read_b32 v93, a137
    v_accvgpr_read_b32 v94, a138
    v_accvgpr_read_b32 v95, a139
    v_accvgpr_read_b32 v96, a140
    v_accvgpr_read_b32 v97, a141
    v_accvgpr_read_b32 v98, a142
    v_accvgpr_read_b32 v99, a143
    v_accvgpr_read_b32 v100, a144
    v_accvgpr_read_b32 v101, a145
    v_accvgpr_read_b32 v102, a146
    v_accvgpr_read_b32 v103, a147
    v_accvgpr_read_b32 v104, a148
    v_accvgpr_read_b32 v105, a149
    v_accvgpr_read_b32 v106, a150
    v_accvgpr_read_b32 v107, a151
    v_pk_fma_f32 v[160:161], v[88:89], v[80:81], v[160:161] op_sel:[0,0,0] op_sel_hi:[1,0,1]
    v_pk_fma_f32 v[162:163], v[90:91], v[80:81], v[162:163] op_sel:[0,0,0] op_sel_hi:[1,0,1]
    ds_write_b128 v5, v[160:163] offset:0
    v_pk_fma_f32 v[164:165], v[92:93], v[80:81], v[164:165] op_sel:[0,0,0] op_sel_hi:[1,0,1]
    v_pk_fma_f32 v[166:167], v[94:95], v[80:81], v[166:167] op_sel:[0,0,0] op_sel_hi:[1,0,1]
    ds_write_b128 v5, v[164:167] offset:1024
    v_pk_fma_f32 v[168:169], v[96:97], v[80:81], v[168:169] op_sel:[0,0,0] op_sel_hi:[1,0,1]
    v_pk_fma_f32 v[170:171], v[98:99], v[80:81], v[170:171] op_sel:[0,0,0] op_sel_hi:[1,0,1]
    ds_write_b128 v5, v[168:171] offset:2048
    v_pk_fma_f32 v[172:173], v[100:101], v[80:81], v[172:173] op_sel:[0,0,0] op_sel_hi:[1,0,1]
    v_pk_fma_f32 v[174:175], v[102:103], v[80:81], v[174:175] op_sel:[0,0,0] op_sel_hi:[1,0,1]
    ds_write_b128 v5, v[172:175] offset:3072
    v_pk_fma_f32 v[176:177], v[104:105], v[80:81], v[176:177] op_sel:[0,0,0] op_sel_hi:[1,0,1]
    v_pk_fma_f32 v[178:179], v[106:107], v[80:81], v[178:179] op_sel:[0,0,0] op_sel_hi:[1,0,1]
    ds_write_b128 v5, v[176:179] offset:4096
    v_pk_fma_f32 v[180:181], v[88:89], v[80:81], v[180:181] op_sel:[0,1,0] op_sel_hi:[1,1,1]
    v_pk_fma_f32 v[182:183], v[90:91], v[80:81], v[182:183] op_sel:[0,1,0] op_sel_hi:[1,1,1]
    ds_write_b128 v5, v[180:183] offset:5120
    v_pk_fma_f32 v[184:185], v[92:93], v[80:81], v[184:185] op_sel:[0,1,0] op_sel_hi:[1,1,1]
    v_pk_fma_f32 v[186:187], v[94:95], v[80:81], v[186:187] op_sel:[0,1,0] op_sel_hi:[1,1,1]
    ds_write_b128 v5, v[184:187] offset:6144
    v_pk_fma_f32 v[188:189], v[96:97], v[80:81], v[188:189] op_sel:[0,1,0] op_sel_hi:[1,1,1]
    v_pk_fma_f32 v[190:191], v[98:99], v[80:81], v[190:191] op_sel:[0,1,0] op_sel_hi:[1,1,1]
    ds_write_b128 v5, v[188:191] offset:7168
    v_pk_fma_f32 v[192:193], v[100:101], v[80:81], v[192:193] op_sel:[0,1,0] op_sel_hi:[1,1,1]
    v_pk_fma_f32 v[194:195], v[102:103], v[80:81], v[194:195] op_sel:[0,1,0] op_sel_hi:[1,1,1]
    ds_write_b128 v5, v[192:195] offset:8192
    v_pk_fma_f32 v[196:197], v[104:105], v[80:81], v[196:197] op_sel:[0,1,0] op_sel_hi:[1,1,1]
    v_pk_fma_f32 v[198:199], v[106:107], v[80:81], v[198:199] op_sel:[0,1,0] op_sel_hi:[1,1,1]
    ds_write_b128 v5, v[196:199] offset:9216
    v_pk_fma_f32 v[200:201], v[88:89], v[82:83], v[200:201] op_sel:[0,0,0] op_sel_hi:[1,0,1]
    v_pk_fma_f32 v[202:203], v[90:91], v[82:83], v[202:203] op_sel:[0,0,0] op_sel_hi:[1,0,1]
    ds_write_b128 v5, v[200:203] offset:10240
    v_pk_fma_f32 v[204:205], v[92:93], v[82:83], v[204:205] op_sel:[0,0,0] op_sel_hi:[1,0,1]
    v_pk_fma_f32 v[206:207], v[94:95], v[82:83], v[206:207] op_sel:[0,0,0] op_sel_hi:[1,0,1]
    ds_write_b128 v5, v[204:207] offset:11264
    v_pk_fma_f32 v[208:209], v[96:97], v[82:83], v[208:209] op_sel:[0,0,0] op_sel_hi:[1,0,1]
    v_pk_fma_f32 v[210:211], v[98:99], v[82:83], v[210:211] op_sel:[0,0,0] op_sel_hi:[1,0,1]
    s_add_u32 m0, s92, 13312
    s_nop 0
    buffer_load_dwordx4 v243, s[20:23], s95 offen lds
    ds_write_b128 v5, v[208:211] offset:12288
    v_pk_fma_f32 v[212:213], v[100:101], v[82:83], v[212:213] op_sel:[0,0,0] op_sel_hi:[1,0,1]
    v_pk_fma_f32 v[214:215], v[102:103], v[82:83], v[214:215] op_sel:[0,0,0] op_sel_hi:[1,0,1]
    ds_write_b128 v5, v[212:215] offset:13312
    v_pk_fma_f32 v[216:217], v[104:105], v[82:83], v[216:217] op_sel:[0,0,0] op_sel_hi:[1,0,1]
    v_pk_fma_f32 v[218:219], v[106:107], v[82:83], v[218:219] op_sel:[0,0,0] op_sel_hi:[1,0,1]
    ds_write_b128 v5, v[216:219] offset:14336
    v_pk_fma_f32 v[220:221], v[88:89], v[82:83], v[220:221] op_sel:[0,1,0] op_sel_hi:[1,1,1]
    v_pk_fma_f32 v[222:223], v[90:91], v[82:83], v[222:223] op_sel:[0,1,0] op_sel_hi:[1,1,1]
    v_pk_fma_f32 v[224:225], v[92:93], v[82:83], v[224:225] op_sel:[0,1,0] op_sel_hi:[1,1,1]
    v_pk_fma_f32 v[226:227], v[94:95], v[82:83], v[226:227] op_sel:[0,1,0] op_sel_hi:[1,1,1]
    v_pk_fma_f32 v[228:229], v[96:97], v[82:83], v[228:229] op_sel:[0,1,0] op_sel_hi:[1,1,1]
    v_pk_fma_f32 v[230:231], v[98:99], v[82:83], v[230:231] op_sel:[0,1,0] op_sel_hi:[1,1,1]
    v_pk_fma_f32 v[232:233], v[100:101], v[82:83], v[232:233] op_sel:[0,1,0] op_sel_hi:[1,1,1]
    v_pk_fma_f32 v[234:235], v[102:103], v[82:83], v[234:235] op_sel:[0,1,0] op_sel_hi:[1,1,1]
    v_pk_fma_f32 v[236:237], v[104:105], v[82:83], v[236:237] op_sel:[0,1,0] op_sel_hi:[1,1,1]
    v_pk_fma_f32 v[238:239], v[106:107], v[82:83], v[238:239] op_sel:[0,1,0] op_sel_hi:[1,1,1]
    s_waitcnt vmcnt(4)
    ds_read_b64_tr_b16 v[120:121], v16 offset:0
    ds_read_b64_tr_b16 v[122:123], v16 offset:2560
    ds_read_b64_tr_b16 v[124:125], v16 offset:8
    ds_read_b64_tr_b16 v[126:127], v16 offset:2568
    ds_read_b64_tr_b16 v[128:129], v14 offset:0
    ds_read_b64_tr_b16 v[130:131], v14 offset:2560
    ds_read_b64_tr_b16 v[132:133], v15 offset:0
    ds_read_b64_tr_b16 v[134:135], v15 offset:2560
    ds_read_b64_tr_b16 v[136:137], v17 offset:128
    ds_read_b64_tr_b16 v[138:139], v17 offset:2688
    v_readfirstlane_b32 s64, v18
    v_readfirstlane_b32 s65, v19
    s_cmp_lg_u32 s65, 0
    s_cbranch_scc1 L_nd_10
    v_mov_b32 v9, 0
    s_mov_b32 s100, 0
L_np_9:
    buffer_load_dwordx2 v[18:19], v9, s[48:51], 0 offen sc1
    s_add_u32 s100, s100, 1
    s_cmp_gt_u32 s100, 200000
    s_waitcnt vmcnt(0)
    v_readfirstlane_b32 s64, v18
    v_readfirstlane_b32 s65, v19
    s_cbranch_scc1 L_nd_10
    s_cmp_eq_u32 s65, 0
    s_cbranch_scc1 L_np_9
L_nd_10:
    s_waitcnt lgkmcnt(0)
    s_barrier
    ds_read_b128 v[160:163], v6 offset:0
    ds_read_b128 v[164:167], v6 offset:1024
    ds_read_b128 v[168:171], v6 offset:2048
    ds_read_b128 v[172:175], v6 offset:3072
    ds_read_b128 v[176:179], v6 offset:4096
    ds_read_b128 v[180:183], v7 offset:0
    ds_read_b128 v[184:187], v7 offset:1024
    ds_read_b128 v[188:191], v7 offset:2048
    ds_read_b128 v[192:195], v7 offset:3072
    ds_read_b128 v[196:199], v7 offset:4096
    ds_read_b128 v[200:203], v8 offset:0
    ds_read_b128 v[204:207], v8 offset:1024
    ds_read_b128 v[208:211], v8 offset:2048
    ds_read_b128 v[212:215], v8 offset:3072
    ds_read_b128 v[216:219], v8 offset:4096
    buffer_store_dwordx4 v[120:123], v4, s[36:39], s78 offen sc1
    buffer_store_dwordx4 v[124:127], v4, s[36:39], s79 offen sc1
    buffer_store_dwordx4 v[128:131], v4, s[36:39], s80 offen sc1
    buffer_store_dwordx4 v[132:135], v4, s[36:39], s81 offen sc1
    buffer_store_dwordx4 v[136:139], v4, s[36:39], s82 offen sc1
    s_waitcnt lgkmcnt(10)
    v_pk_add_f32 v[220:221], v[220:221], v[160:161]
    v_pk_add_f32 v[222:223], v[222:223], v[162:163]
    v_pk_add_f32 v[224:225], v[224:225], v[164:165]
    v_pk_add_f32 v[226:227], v[226:227], v[166:167]
    v_pk_add_f32 v[228:229], v[228:229], v[168:169]
    v_pk_add_f32 v[230:231], v[230:231], v[170:171]
    v_pk_add_f32 v[232:233], v[232:233], v[172:173]
    v_pk_add_f32 v[234:235], v[234:235], v[174:175]
    v_pk_add_f32 v[236:237], v[236:237], v[176:177]
    v_pk_add_f32 v[238:239], v[238:239], v[178:179]
    s_waitcnt lgkmcnt(5)
    v_pk_add_f32 v[220:221], v[220:221], v[180:181]
    s_add_u32 m0, s92, 14336
    s_nop 0
    buffer_load_dwordx4 v244, s[20:23], s95 offen lds
    v_pk_add_f32 v[222:223], v[222:223], v[182:183]
    v_pk_add_f32 v[224:225], v[224:225], v[184:185]
    v_pk_add_f32 v[226:227], v[226:227], v[186:187]
    v_pk_add_f32 v[228:229], v[228:229], v[188:189]
    v_pk_add_f32 v[230:231], v[230:231], v[190:191]
    v_pk_add_f32 v[232:233], v[232:233], v[192:193]
    v_pk_add_f32 v[234:235], v[234:235], v[194:195]
    v_pk_add_f32 v[236:237], v[236:237], v[196:197]
    v_pk_add_f32 v[238:239], v[238:239], v[198:199]
    s_waitcnt lgkmcnt(0)
    v_pk_add_f32 v[220:221], v[220:221], v[200:201]
    v_pk_add_f32 v[222:223], v[222:223], v[202:203]
    v_pk_add_f32 v[224:225], v[224:225], v[204:205]
    v_pk_add_f32 v[226:227], v[226:227], v[206:207]
    v_pk_add_f32 v[228:229], v[228:229], v[208:209]
    v_pk_add_f32 v[230:231], v[230:231], v[210:211]
    v_pk_add_f32 v[232:233], v[232:233], v[212:213]
    v_pk_add_f32 v[234:235], v[234:235], v[214:215]
    v_pk_add_f32 v[236:237], v[236:237], v[216:217]
    v_pk_add_f32 v[238:239], v[238:239], v[218:219]
    v_pk_mul_f32 v[220:221], v[220:221], v[84:85] op_sel_hi:[1,0]
    v_pk_mul_f32 v[222:223], v[222:223], v[84:85] op_sel_hi:[1,0]
    v_pk_mul_f32 v[224:225], v[224:225], v[84:85] op_sel_hi:[1,0]
    v_pk_mul_f32 v[226:227], v[226:227], v[84:85] op_sel_hi:[1,0]
    v_pk_mul_f32 v[228:229], v[228:229], v[84:85] op_sel_hi:[1,0]
    v_pk_mul_f32 v[230:231], v[230:231], v[84:85] op_sel_hi:[1,0]
    v_pk_mul_f32 v[232:233], v[232:233], v[84:85] op_sel_hi:[1,0]
    v_pk_mul_f32 v[234:235], v[234:235], v[84:85] op_sel_hi:[1,0]
    v_pk_mul_f32 v[236:237], v[236:237], v[84:85] op_sel_hi:[1,0]
    v_pk_mul_f32 v[238:239], v[238:239], v[84:85] op_sel_hi:[1,0]
    v_pk_mul_f32 v[100:101], v[220:221], v[220:221]
    v_pk_mul_f32 v[102:103], v[222:223], v[222:223]
    v_pk_mul_f32 v[104:105], v[224:225], v[224:225]
    v_pk_mul_f32 v[106:107], v[226:227], v[226:227]
    v_pk_mul_f32 v[108:109], v[228:229], v[228:229]
    v_pk_mul_f32 v[110:111], v[230:231], v[230:231]
    v_pk_mul_f32 v[112:113], v[232:233], v[232:233]
    v_pk_mul_f32 v[114:115], v[234:235], v[234:235]
    v_pk_mul_f32 v[116:117], v[236:237], v[236:237]
    v_pk_mul_f32 v[118:119], v[238:239], v[238:239]
    v_pk_fma_f32 v[100:101], v[100:101], s[94:95], v[22:23] op_sel_hi:[1,0,0]
    v_pk_fma_f32 v[102:103], v[102:103], s[94:95], v[22:23] op_sel_hi:[1,0,0]
    v_pk_fma_f32 v[104:105], v[104:105], s[94:95], v[22:23] op_sel_hi:[1,0,0]
    v_pk_fma_f32 v[106:107], v[106:107], s[94:95], v[22:23] op_sel_hi:[1,0,0]
    v_pk_fma_f32 v[108:109], v[108:109], s[94:95], v[22:23] op_sel_hi:[1,0,0]
    v_pk_fma_f32 v[110:111], v[110:111], s[94:95], v[22:23] op_sel_hi:[1,0,0]
    v_pk_fma_f32 v[112:113], v[112:113], s[94:95], v[22:23] op_sel_hi:[1,0,0]
    v_pk_fma_f32 v[114:115], v[114:115], s[94:95], v[22:23] op_sel_hi:[1,0,0]
    s_add_u32 s95, s3, 3
    s_and_b32 s95, s95, 3
    s_mul_i32 s95, s95, 40960
    s_add_u32 s95, s95, s85
    s_add_u32 m0, s92, 15360
    s_nop 0
    buffer_load_dwordx4 v240, s[20:23], s95 offen lds
    v_pk_fma_f32 v[116:117], v[116:117], s[94:95], v[22:23] op_sel_hi:[1,0,0]
    v_pk_fma_f32 v[118:119], v[118:119], s[94:95], v[22:23] op_sel_hi:[1,0,0]
    v_pk_mul_f32 v[100:101], v[100:101], v[220:221]
    v_pk_mul_f32 v[102:103], v[102:103], v[222:223]
    v_pk_mul_f32 v[104:105], v[104:105], v[224:225]
    v_pk_mul_f32 v[106:107], v[106:107], v[226:227]
    v_pk_mul_f32 v[108:109], v[108:109], v[228:229]
    v_pk_mul_f32 v[110:111], v[110:111], v[230:231]
    v_pk_mul_f32 v[112:113], v[112:113], v[232:233]
    v_pk_mul_f32 v[114:115], v[114:115], v[234:235]
    v_pk_mul_f32 v[116:117], v[116:117], v[236:237]
    v_pk_mul_f32 v[118:119], v[118:119], v[238:239]
    v_exp_f32 v100, v100
    v_exp_f32 v101, v101
    v_exp_f32 v102, v102
    s_add_u32 m0, s92, 16384
    s_nop 0
    buffer_load_dwordx4 v241, s[20:23], s95 offen lds
    v_exp_f32 v103, v103
    v_exp_f32 v104, v104
    v_exp_f32 v105, v105
    v_exp_f32 v106, v106
    v_exp_f32 v107, v107
    v_exp_f32 v108, v108
    v_exp_f32 v109, v109
    v_exp_f32 v110, v110
    v_exp_f32 v111, v111
    s_add_u32 m0, s92, 17408
    s_nop 0
    buffer_load_dwordx4 v242, s[20:23], s95 offen lds
    v_exp_f32 v112, v112
    v_exp_f32 v113, v113
    v_exp_f32 v114, v114
    v_exp_f32 v115, v115
    v_exp_f32 v116, v116
    v_exp_f32 v117, v117
    v_exp_f32 v118, v118
    v_exp_f32 v119, v119
    s_add_u32 m0, s92, 18432
    s_nop 0
    buffer_load_dwordx4 v243, s[20:23], s95 offen lds
    v_pk_add_f32 v[100:101], v[100:101], 1.0 op_sel_hi:[1,0]
    v_pk_add_f32 v[102:103], v[102:103], 1.0 op_sel_hi:[1,0]
    v_pk_add_f32 v[104:105], v[104:105], 1.0 op_sel_hi:[1,0]
    v_pk_add_f32 v[106:107], v[106:107], 1.0 op_sel_hi:[1,0]
    v_pk_add_f32 v[108:109], v[108:109], 1.0 op_sel_hi:[1,0]
    v_pk_add_f32 v[110:111], v[110:111], 1.0 op_sel_hi:[1,0]
    v_pk_add_f32 v[112:113], v[112:113], 1.0 op_sel_hi:[1,0]
    v_pk_add_f32 v[114:115], v[114:115], 1.0 op_sel_hi:[1,0]
    v_pk_add_f32 v[116:117], v[116:117], 1.0 op_sel_hi:[1,0]
    v_pk_add_f32 v[118:119], v[118:119], 1.0 op_sel_hi:[1,0]
    v_rcp_f32 v100, v100
    v_rcp_f32 v101, v101
    v_rcp_f32 v102, v102
    v_rcp_f32 v103, v103
    s_add_u32 m0, s92, 19456
    s_nop 0
    buffer_load_dwordx4 v244, s[20:23], s95 offen lds
    v_rcp_f32 v104, v104
    v_rcp_f32 v105, v105
    v_rcp_f32 v106, v106
    v_rcp_f32 v107, v107
    v_rcp_f32 v108, v108
    v_rcp_f32 v109, v109
    v_rcp_f32 v110, v110
    v_rcp_f32 v111, v111
    v_rcp_f32 v112, v112
    v_rcp_f32 v113, v113
    v_rcp_f32 v114, v114
    v_rcp_f32 v115, v115
    v_rcp_f32 v116, v116
    v_rcp_f32 v117, v117
    v_rcp_f32 v118, v118
    v_rcp_f32 v119, v119
    v_pk_mul_f32 v[220:221], v[220:221], v[100:101]
    v_pk_mul_f32 v[222:223], v[222:223], v[102:103]
    v_pk_mul_f32 v[224:225], v[224:225], v[104:105]
    v_pk_mul_f32 v[226:227], v[226:227], v[106:107]
    v_pk_mul_f32 v[228:229], v[228:229], v[108:109]
    v_pk_mul_f32 v[230:231], v[230:231], v[110:111]
    v_pk_mul_f32 v[232:233], v[232:233], v[112:113]
    v_pk_mul_f32 v[234:235], v[234:235], v[114:115]
    v_pk_mul_f32 v[236:237], v[236:237], v[116:117]
    v_pk_mul_f32 v[238:239], v[238:239], v[118:119]
    v_cvt_pk_bf16_f32 v80, v220, v221
    v_cvt_pk_bf16_f32 v81, v222, v223
    v_cvt_pk_bf16_f32 v82, v224, v225
    v_cvt_pk_bf16_f32 v83, v226, v227
    v_cvt_pk_bf16_f32 v84, v228, v229
    v_cvt_pk_bf16_f32 v85, v230, v231
    v_cvt_pk_bf16_f32 v86, v232, v233
    v_cvt_pk_bf16_f32 v87, v234, v235
    v_cvt_pk_bf16_f32 v88, v236, v237
    v_cvt_pk_bf16_f32 v89, v238, v239
    buffer_store_dwordx4 v[80:83], v20, s[36:39], 0 offen sc1
    buffer_store_dwordx4 v[84:87], v20, s[36:39], s30 offen sc1
    buffer_store_dwordx2 v[88:89], v21, s[36:39], s31 offen sc1
    v_bfe_u32 v209, v1, 3, 2
    v_lshlrev_b32 v209, 7, v209
    v_and_b32 v9, 7, v1
    v_lshl_add_u32 v209, v9, 3, v209
    v_accvgpr_read_b32 v116, a156
    v_accvgpr_read_b32 v117, a157
    v_accvgpr_read_b32 v118, a158
    v_accvgpr_read_b32 v119, a159
    v_accvgpr_read_b32 v120, a160
    v_accvgpr_read_b32 v121, a161
    v_accvgpr_read_b32 v122, a162
    v_accvgpr_read_b32 v123, a163
    v_lshlrev_b32 v92, 16, v116
    v_and_b32 v96, s63, v116
    v_lshlrev_b32 v100, 16, v117
    v_and_b32 v104, s63, v117
    v_lshlrev_b32 v93, 16, v118
    v_and_b32 v97, s63, v118
    v_lshlrev_b32 v101, 16, v119
    v_and_b32 v105, s63, v119
    v_lshlrev_b32 v94, 16, v120
    v_and_b32 v98, s63, v120
    v_lshlrev_b32 v102, 16, v121
    v_and_b32 v106, s63, v121
    v_lshlrev_b32 v95, 16, v122
    v_and_b32 v99, s63, v122
    v_lshlrev_b32 v103, 16, v123
    v_and_b32 v107, s63, v123
    v_lshlrev_b32 v108, 16, v48
    v_and_b32 v109, s63, v48
    v_lshlrev_b32 v110, 16, v50
    v_and_b32 v111, s63, v50
    v_lshlrev_b32 v112, 16, v52
    v_and_b32 v113, s63, v52
    v_lshlrev_b32 v114, 16, v54
    v_and_b32 v115, s63, v54
    v_lshlrev_b32 v134, 16, v34
    v_and_b32 v135, s63, v34
    v_pk_mul_f32 v[116:117], v[114:115], v[92:93]
    v_pk_fma_f32 v[116:117], v[112:113], v[96:97], v[116:117]
    v_pk_fma_f32 v[116:117], v[110:111], v[100:101], v[116:117]
    v_pk_fma_f32 v[116:117], v[108:109], v[104:105], v[116:117]
    v_pk_mul_f32 v[116:117], v[116:117], v[134:135]
    v_lshlrev_b32 v108, 16, v56
    v_and_b32 v109, s63, v56
    v_lshlrev_b32 v134, 16, v36
    v_and_b32 v135, s63, v36
    v_pk_mul_f32 v[118:119], v[108:109], v[92:93]
    v_pk_fma_f32 v[118:119], v[114:115], v[96:97], v[118:119]
    v_pk_fma_f32 v[118:119], v[112:113], v[100:101], v[118:119]
    v_pk_fma_f32 v[118:119], v[110:111], v[104:105], v[118:119]
    v_pk_mul_f32 v[118:119], v[118:119], v[134:135]
    v_lshlrev_b32 v110, 16, v58
    v_and_b32 v111, s63, v58
    v_lshlrev_b32 v134, 16, v38
    v_and_b32 v135, s63, v38
    v_pk_mul_f32 v[120:121], v[110:111], v[92:93]
    v_pk_fma_f32 v[120:121], v[108:109], v[96:97], v[120:121]
    v_pk_fma_f32 v[120:121], v[114:115], v[100:101], v[120:121]
    v_pk_fma_f32 v[120:121], v[112:113], v[104:105], v[120:121]
    v_pk_mul_f32 v[120:121], v[120:121], v[134:135]
    v_lshlrev_b32 v112, 16, v60
    v_and_b32 v113, s63, v60
    v_lshlrev_b32 v134, 16, v40
    v_and_b32 v135, s63, v40
    v_pk_mul_f32 v[122:123], v[112:113], v[92:93]
    v_pk_fma_f32 v[122:123], v[110:111], v[96:97], v[122:123]
    v_pk_fma_f32 v[122:123], v[108:109], v[100:101], v[122:123]
    v_pk_fma_f32 v[122:123], v[114:115], v[104:105], v[122:123]
    v_pk_mul_f32 v[122:123], v[122:123], v[134:135]
    v_lshlrev_b32 v114, 16, v62
    v_and_b32 v115, s63, v62
    v_lshlrev_b32 v134, 16, v42
    v_and_b32 v135, s63, v42
    v_pk_mul_f32 v[124:125], v[114:115], v[92:93]
    v_pk_fma_f32 v[124:125], v[112:113], v[96:97], v[124:125]
    v_pk_fma_f32 v[124:125], v[110:111], v[100:101], v[124:125]
    v_pk_fma_f32 v[124:125], v[108:109], v[104:105], v[124:125]
    v_pk_mul_f32 v[124:125], v[124:125], v[134:135]
    v_lshlrev_b32 v108, 16, v64
    v_and_b32 v109, s63, v64
    v_lshlrev_b32 v134, 16, v72
    v_and_b32 v135, s63, v72
    v_pk_mul_f32 v[126:127], v[108:109], v[92:93]
    v_pk_fma_f32 v[126:127], v[114:115], v[96:97], v[126:127]
    v_pk_fma_f32 v[126:127], v[112:113], v[100:101], v[126:127]
    v_pk_fma_f32 v[126:127], v[110:111], v[104:105], v[126:127]
    v_pk_mul_f32 v[126:127], v[126:127], v[134:135]
    v_lshlrev_b32 v110, 16, v66
    v_and_b32 v111, s63, v66
    v_lshlrev_b32 v134, 16, v74
    v_and_b32 v135, s63, v74
    v_pk_mul_f32 v[128:129], v[110:111], v[92:93]
    v_pk_fma_f32 v[128:129], v[108:109], v[96:97], v[128:129]
    v_pk_fma_f32 v[128:129], v[114:115], v[100:101], v[128:129]
    v_pk_fma_f32 v[128:129], v[112:113], v[104:105], v[128:129]
    v_pk_mul_f32 v[128:129], v[128:129], v[134:135]
    v_lshlrev_b32 v112, 16, v68
    v_and_b32 v113, s63, v68
    v_lshlrev_b32 v134, 16, v76
    v_and_b32 v135, s63, v76
    v_pk_mul_f32 v[130:131], v[112:113], v[92:93]
    v_pk_fma_f32 v[130:131], v[110:111], v[96:97], v[130:131]
    v_pk_fma_f32 v[130:131], v[108:109], v[100:101], v[130:131]
    v_pk_fma_f32 v[130:131], v[114:115], v[104:105], v[130:131]
    v_pk_mul_f32 v[130:131], v[130:131], v[134:135]
    v_lshlrev_b32 v114, 16, v70
    v_and_b32 v115, s63, v70
    v_lshlrev_b32 v134, 16, v78
    v_and_b32 v135, s63, v78
    v_pk_mul_f32 v[132:133], v[114:115], v[92:93]
    v_pk_fma_f32 v[132:133], v[112:113], v[96:97], v[132:133]
    v_pk_fma_f32 v[132:133], v[110:111], v[100:101], v[132:133]
    v_pk_fma_f32 v[132:133], v[108:109], v[104:105], v[132:133]
    v_pk_mul_f32 v[132:133], v[132:133], v[134:135]
    v_cvt_pk_bf16_f32 v140, v132, v130
    v_cvt_pk_bf16_f32 v141, v128, v126
    v_cvt_pk_bf16_f32 v142, v124, v122
    v_cvt_pk_bf16_f32 v143, v120, v118
    v_cvt_pk_bf16_f32 v136, v130, v128
    v_cvt_pk_bf16_f32 v137, v126, v124
    v_cvt_pk_bf16_f32 v138, v122, v120
    v_cvt_pk_bf16_f32 v139, v118, v116
    v_cvt_pk_bf16_f32 v148, v133, v131
    v_cvt_pk_bf16_f32 v149, v129, v127
    v_cvt_pk_bf16_f32 v150, v125, v123
    v_cvt_pk_bf16_f32 v151, v121, v119
    v_cvt_pk_bf16_f32 v144, v131, v129
    v_cvt_pk_bf16_f32 v145, v127, v125
    v_cvt_pk_bf16_f32 v146, v123, v121
    v_cvt_pk_bf16_f32 v147, v119, v117
    s_waitcnt vmcnt(0)
    s_barrier
    s_cmp_lg_u32 s58, 0
    s_cbranch_scc1 L_nofl_11
    v_mov_b32 v10, s64
    v_mov_b32 v11, s65
    v_mov_b32 v12, 0x0
    s_mov_b64 exec, 1
    buffer_store_dwordx2 v[10:11], v12, s[36:39], s24 offen sc1
    s_mov_b64 exec, -1
L_nofl_11:
    s_cmp_lg_u32 s58, 1
    s_cbranch_scc1 L_nofl_12
    v_mov_b32 v10, s64
    v_mov_b32 v11, s65
    v_mov_b32 v12, 0x0
    s_mov_b64 exec, 1
    buffer_store_dwordx2 v[10:11], v12, s[36:39], s26 offen sc1
    s_mov_b64 exec, -1
L_nofl_12:
    v_lshlrev_b32 v108, 16, v49
    v_and_b32 v109, s63, v49
    v_lshlrev_b32 v110, 16, v51
    v_and_b32 v111, s63, v51
    v_lshlrev_b32 v112, 16, v53
    v_and_b32 v113, s63, v53
    v_lshlrev_b32 v114, 16, v55
    v_and_b32 v115, s63, v55
    v_lshlrev_b32 v134, 16, v35
    v_and_b32 v135, s63, v35
    v_pk_mul_f32 v[116:117], v[114:115], v[94:95]
    v_pk_fma_f32 v[116:117], v[112:113], v[98:99], v[116:117]
    v_pk_fma_f32 v[116:117], v[110:111], v[102:103], v[116:117]
    v_pk_fma_f32 v[116:117], v[108:109], v[106:107], v[116:117]
    v_pk_mul_f32 v[116:117], v[116:117], v[134:135]
    v_lshlrev_b32 v108, 16, v57
    v_and_b32 v109, s63, v57
    v_lshlrev_b32 v134, 16, v37
    v_and_b32 v135, s63, v37
    v_pk_mul_f32 v[118:119], v[108:109], v[94:95]
    v_pk_fma_f32 v[118:119], v[114:115], v[98:99], v[118:119]
    s_add_u32 s95, s85, 163840
    s_add_u32 m0, s61, 0
    s_nop 0
    buffer_load_dwordx4 v240, s[20:23], s95 offen lds
    v_pk_fma_f32 v[118:119], v[112:113], v[102:103], v[118:119]
    v_pk_fma_f32 v[118:119], v[110:111], v[106:107], v[118:119]
    v_pk_mul_f32 v[118:119], v[118:119], v[134:135]
    v_lshlrev_b32 v110, 16, v59
    v_and_b32 v111, s63, v59
    v_lshlrev_b32 v134, 16, v39
    v_and_b32 v135, s63, v39
    v_pk_mul_f32 v[120:121], v[110:111], v[94:95]
    v_pk_fma_f32 v[120:121], v[108:109], v[98:99], v[120:121]
    v_pk_fma_f32 v[120:121], v[114:115], v[102:103], v[120:121]
    v_pk_fma_f32 v[120:121], v[112:113], v[106:107], v[120:121]
    v_pk_mul_f32 v[120:121], v[120:121], v[134:135]
    v_lshlrev_b32 v112, 16, v61
    v_and_b32 v113, s63, v61
    v_lshlrev_b32 v134, 16, v41
    v_and_b32 v135, s63, v41
    v_pk_mul_f32 v[122:123], v[112:113], v[94:95]
    v_pk_fma_f32 v[122:123], v[110:111], v[98:99], v[122:123]
    v_pk_fma_f32 v[122:123], v[108:109], v[102:103], v[122:123]
    v_pk_fma_f32 v[122:123], v[114:115], v[106:107], v[122:123]
    s_add_u32 m0, s61, 1024
    s_nop 0
    buffer_load_dwordx4 v241, s[20:23], s95 offen lds
    v_pk_mul_f32 v[122:123], v[122:123], v[134:135]
    v_lshlrev_b32 v114, 16, v63
    v_and_b32 v115, s63, v63
    v_lshlrev_b32 v134, 16, v43
    v_and_b32 v135, s63, v43
    v_pk_mul_f32 v[124:125], v[114:115], v[94:95]
    v_pk_fma_f32 v[124:125], v[112:113], v[98:99], v[124:125]
    v_pk_fma_f32 v[124:125], v[110:111], v[102:103], v[124:125]
    v_pk_fma_f32 v[124:125], v[108:109], v[106:107], v[124:125]
    v_pk_mul_f32 v[124:125], v[124:125], v[134:135]
    v_lshlrev_b32 v108, 16, v65
    v_and_b32 v109, s63, v65
    v_lshlrev_b32 v134, 16, v73
    v_and_b32 v135, s63, v73
    v_pk_mul_f32 v[126:127], v[108:109], v[94:95]
    v_pk_fma_f32 v[126:127], v[114:115], v[98:99], v[126:127]
    v_pk_fma_f32 v[126:127], v[112:113], v[102:103], v[126:127]
    v_pk_fma_f32 v[126:127], v[110:111], v[106:107], v[126:127]
    v_pk_mul_f32 v[126:127], v[126:127], v[134:135]
    v_lshlrev_b32 v110, 16, v67
    s_add_u32 m0, s61, 2048
    s_nop 0
    buffer_load_dwordx4 v242, s[20:23], s95 offen lds
    v_and_b32 v111, s63, v67
    v_lshlrev_b32 v134, 16, v75
    v_and_b32 v135, s63, v75
    v_pk_mul_f32 v[128:129], v[110:111], v[94:95]
    v_pk_fma_f32 v[128:129], v[108:109], v[98:99], v[128:129]
    v_pk_fma_f32 v[128:129], v[114:115], v[102:103], v[128:129]
    v_pk_fma_f32 v[128:129], v[112:113], v[106:107], v[128:129]
    v_pk_mul_f32 v[128:129], v[128:129], v[134:135]
    v_lshlrev_b32 v112, 16, v69
    v_and_b32 v113, s63, v69
    v_lshlrev_b32 v134, 16, v77
    v_and_b32 v135, s63, v77
    v_pk_mul_f32 v[130:131], v[112:113], v[94:95]
    v_pk_fma_f32 v[130:131], v[110:111], v[98:99], v[130:131]
    v_pk_fma_f32 v[130:131], v[108:109], v[102:103], v[130:131]
    v_pk_fma_f32 v[130:131], v[114:115], v[106:107], v[130:131]
    v_pk_mul_f32 v[130:131], v[130:131], v[134:135]
    v_lshlrev_b32 v114, 16, v71
    v_and_b32 v115, s63, v71
    v_lshlrev_b32 v134, 16, v79
    v_and_b32 v135, s63, v79
    s_add_u32 m0, s61, 3072
    s_nop 0
    buffer_load_dwordx4 v243, s[20:23], s95 offen lds
    v_pk_mul_f32 v[132:133], v[114:115], v[94:95]
    v_pk_fma_f32 v[132:133], v[112:113], v[98:99], v[132:133]
    v_pk_fma_f32 v[132:133], v[110:111], v[102:103], v[132:133]
    v_pk_fma_f32 v[132:133], v[108:109], v[106:107], v[132:133]
    v_pk_mul_f32 v[132:133], v[132:133], v[134:135]
    v_cvt_pk_bf16_f32 v156, v132, v130
    v_cvt_pk_bf16_f32 v157, v128, v126
    v_cvt_pk_bf16_f32 v158, v124, v122
    v_cvt_pk_bf16_f32 v159, v120, v118
    v_cvt_pk_bf16_f32 v152, v130, v128
    v_cvt_pk_bf16_f32 v153, v126, v124
    v_cvt_pk_bf16_f32 v154, v122, v120
    v_cvt_pk_bf16_f32 v155, v118, v116
    v_cvt_pk_bf16_f32 v164, v133, v131
    v_cvt_pk_bf16_f32 v165, v129, v127
    v_cvt_pk_bf16_f32 v166, v125, v123
    v_cvt_pk_bf16_f32 v167, v121, v119
    v_cvt_pk_bf16_f32 v160, v131, v129
    v_cvt_pk_bf16_f32 v161, v127, v125
    v_cvt_pk_bf16_f32 v162, v123, v121
    s_add_u32 m0, s61, 4096
    s_nop 0
    buffer_load_dwordx4 v244, s[20:23], s95 offen lds
    v_cvt_pk_bf16_f32 v163, v119, v117
    s_mov_b32 exec_hi, 0xff
    ds_write_b128 v254, v[140:143] offset:30720
    ds_write_b128 v254, v[136:139] offset:0
    ds_write_b128 v254, v[148:151] offset:30848
    ds_write_b128 v254, v[144:147] offset:128
    ds_write_b128 v254, v[156:159] offset:30976
    ds_write_b128 v254, v[152:155] offset:256
    ds_write_b128 v254, v[164:167] offset:31104
    ds_write_b128 v254, v[160:163] offset:384
    s_mov_b32 exec_hi, -1
    s_bitcmp1_b32 s58, 0
    s_cselect_b32 s70, 1, -1
    s_add_u32 s71, s70, s56
    s_lshl_b32 s70, s70, 7
    s_cmp_lt_u32 s71, 32
    s_cselect_b32 s70, s70, 0
    v_bfe_u32 v17, v1, 1, 1
    v_mul_lo_u32 v17, s70, v17
    v_and_b32 v9, 1, v1
    v_lshl_add_u32 v17, v9, 3, v17
    s_lshl_b32 s70, s56, 7
    s_lshl_b32 s71, s58, 4
    s_add_u32 s70, s70, s71
    s_add_u32 s70, s70, 0x1d00000
    v_add_u32 v17, s70, v17
    v_lshrrev_b32 v14, 5, v1
    v_and_b32 v15, 7, v1
    v_xor_b32 v14, v14, v15
    v_lshlrev_b32 v14, 4, v14
    v_lshrrev_b32 v13, 3, v1
    v_lshl_add_u32 v14, v13, 7, v14
    v_add_u32 v14, s61, v14
    v_lshlrev_b32 v15, 4, v15
    v_lshl_add_u32 v15, v13, 12, v15
    s_lshr_b32 s27, s69, 1
    s_mul_i32 s27, s27, 640
    s_and_b32 s71, s69, 1
    s_mul_i32 s71, s71, 40
    s_add_u32 s27, s27, s71
    s_mul_i32 s71, s57, 80
    s_add_u32 s27, s27, s71
    s_lshl_b32 s27, s27, 12
    s_lshl_b32 s71, s56, 7
    s_sub_u32 s27, s27, s71
    s_add_u32 s27, s27, 0x1300f80
    buffer_load_dwordx2 v[18:19], v17, s[36:39], 0 offen sc1
    buffer_load_dwordx2 v[210:211], v209, s[36:39], s25 offen sc1
    s_waitcnt lgkmcnt(0)
    s_barrier
    v_xor_b32 v13, 0, v14
    ds_read_b128 v[92:95], v13 offset:5120
    v_xor_b32 v13, 32, v14
    ds_read_b128 v[96:99], v13 offset:6144
    v_xor_b32 v13, 64, v14
    ds_read_b128 v[100:103], v13 offset:7168
    v_xor_b32 v13, 96, v14
    ds_read_b128 v[104:107], v13 offset:8192
    v_xor_b32 v13, 0, v14
    ds_read_b128 v[108:111], v13 offset:9216
    s_lshr_b32 s75, s58, 1
    s_add_u32 s75, s75, 1
    s_sub_u32 s76, 0, s75
    s_bitcmp1_b32 s58, 0
    s_cselect_b32 s75, s75, s76
    s_lshl_b32 s76, s56, 6
    s_add_u32 s75, s75, s76
    v_add_u32 v13, s75, v2
    v_lshlrev_b32 v16, 15, v3
    v_lshl_add_u32 v200, s66, 4, v13
    v_cmp_gt_u32 vcc, 2048, v200
    v_lshl_add_u32 v200, v200, 4, v16
    s_nop 0
    v_cndmask_b32 v200, -2.0, v200, vcc
    v_lshl_add_u32 v201, s67, 4, v13
    v_cmp_gt_u32 vcc, 2048, v201
    v_lshl_add_u32 v201, v201, 4, v16
    s_nop 0
    v_cndmask_b32 v201, -2.0, v201, vcc
    v_lshl_add_u32 v202, s68, 4, v13
    v_cmp_gt_u32 vcc, 2048, v202
    v_lshl_add_u32 v202, v202, 4, v16
    s_nop 0
    v_cndmask_b32 v202, -2.0, v202, vcc
    v_lshl_add_u32 v203, s69, 4, v13
    v_cmp_gt_u32 vcc, 2048, v203
    v_lshl_add_u32 v203, v203, 4, v16
    s_nop 0
    v_cndmask_b32 v203, -2.0, v203, vcc
    s_mul_i32 s76, s58, 655360
    s_add_u32 s4, s3, 0
    s_and_b32 s4, s4, 3
    s_lshl_b32 s4, s4, 17
    s_add_u32 s4, s4, s76
    s_add_u32 s5, s3, 1
    s_and_b32 s5, s5, 3
    s_lshl_b32 s5, s5, 17
    s_add_u32 s5, s5, s76
    s_add_u32 s6, s3, 2
    s_and_b32 s6, s6, 3
    s_lshl_b32 s6, s6, 17
    s_add_u32 s6, s6, s76
    s_add_u32 s7, s3, 3
    s_and_b32 s7, s7, 3
    s_lshl_b32 s7, s7, 17
    s_add_u32 s7, s7, s76
    s_add_u32 s95, s76, 524288
    s_waitcnt lgkmcnt(0)
    buffer_store_dwordx4 v[92:95], v15, s[36:39], s27 offen sc1
    s_add_u32 s27, s27, 32768
    buffer_store_dwordx4 v[96:99], v15, s[36:39], s27 offen sc1
    s_add_u32 s27, s27, 32768
    buffer_store_dwordx4 v[100:103], v15, s[36:39], s27 offen sc1
    s_add_u32 s27, s27, 32768
    buffer_store_dwordx4 v[104:107], v15, s[36:39], s27 offen sc1
    s_add_u32 s27, s27, 32768
    buffer_store_dwordx4 v[108:111], v15, s[36:39], s27 offen sc1
    v_lshlrev_b32 v220, 16, v24
    v_and_b32 v221, s63, v24
    v_lshlrev_b32 v222, 16, v25
    v_and_b32 v223, s63, v25
    v_lshlrev_b32 v224, 16, v26
    v_and_b32 v225, s63, v26
    v_lshlrev_b32 v226, 16, v27
    v_and_b32 v227, s63, v27
    v_lshlrev_b32 v228, 16, v28
    v_and_b32 v229, s63, v28
    v_lshlrev_b32 v230, 16, v29
    v_and_b32 v231, s63, v29
    v_lshlrev_b32 v232, 16, v30
    v_and_b32 v233, s63, v30
    v_lshlrev_b32 v234, 16, v31
    v_and_b32 v235, s63, v31
    v_lshlrev_b32 v236, 16, v32
    v_and_b32 v237, s63, v32
    v_lshlrev_b32 v238, 16, v33
    v_and_b32 v239, s63, v33
    v_pk_fma_f32 v[220:221], v[220:221], v[44:45], v[44:45] op_sel:[0,0,1] op_sel_hi:[1,0,1]
    v_pk_fma_f32 v[222:223], v[222:223], v[44:45], v[44:45] op_sel:[0,0,1] op_sel_hi:[1,0,1]
    v_pk_fma_f32 v[224:225], v[224:225], v[44:45], v[44:45] op_sel:[0,0,1] op_sel_hi:[1,0,1]
    v_pk_fma_f32 v[226:227], v[226:227], v[44:45], v[44:45] op_sel:[0,0,1] op_sel_hi:[1,0,1]
    v_pk_fma_f32 v[228:229], v[228:229], v[44:45], v[44:45] op_sel:[0,0,1] op_sel_hi:[1,0,1]
    v_pk_fma_f32 v[230:231], v[230:231], v[44:45], v[44:45] op_sel:[0,0,1] op_sel_hi:[1,0,1]
    v_pk_fma_f32 v[232:233], v[232:233], v[44:45], v[44:45] op_sel:[0,0,1] op_sel_hi:[1,0,1]
    v_pk_fma_f32 v[234:235], v[234:235], v[44:45], v[44:45] op_sel:[0,0,1] op_sel_hi:[1,0,1]
    v_pk_fma_f32 v[236:237], v[236:237], v[44:45], v[44:45] op_sel:[0,0,1] op_sel_hi:[1,0,1]
    v_pk_fma_f32 v[238:239], v[238:239], v[44:45], v[44:45] op_sel:[0,0,1] op_sel_hi:[1,0,1]
    s_waitcnt vmcnt(7)
    ds_read_b64_tr_b16 a[0:1], v252 offset:0
    ds_read_b64_tr_b16 a[2:3], v252 offset:2560
    ds_read_b64_tr_b16 a[4:5], v252 offset:8
    ds_read_b64_tr_b16 a[6:7], v252 offset:2568
    ds_read_b64_tr_b16 a[8:9], v252 offset:64
    ds_read_b64_tr_b16 a[10:11], v252 offset:2624
    ds_read_b64_tr_b16 a[12:13], v252 offset:72
    ds_read_b64_tr_b16 a[14:15], v252 offset:2632
    ds_read_b64_tr_b16 a[16:17], v253 offset:128
    ds_read_b64_tr_b16 a[18:19], v253 offset:2688
    ds_read_b64_tr_b16 a[20:21], v252 offset:5120
    ds_read_b64_tr_b16 a[22:23], v252 offset:7680
    ds_read_b64_tr_b16 a[24:25], v252 offset:5128
    ds_read_b64_tr_b16 a[26:27], v252 offset:7688
    ds_read_b64_tr_b16 a[28:29], v252 offset:5184
    ds_read_b64_tr_b16 a[30:31], v252 offset:7744
    ds_read_b64_tr_b16 a[32:33], v252 offset:5192
    ds_read_b64_tr_b16 a[34:35], v252 offset:7752
    ds_read_b64_tr_b16 a[36:37], v253 offset:5248
    ds_read_b64_tr_b16 a[38:39], v253 offset:7808
    ds_read_b64_tr_b16 a[40:41], v252 offset:10240
    ds_read_b64_tr_b16 a[42:43], v252 offset:12800
    ds_read_b64_tr_b16 a[44:45], v252 offset:10248
    ds_read_b64_tr_b16 a[46:47], v252 offset:12808
    ds_read_b64_tr_b16 a[48:49], v252 offset:10304
    ds_read_b64_tr_b16 a[50:51], v252 offset:12864
    ds_read_b64_tr_b16 a[52:53], v252 offset:10312
    ds_read_b64_tr_b16 a[54:55], v252 offset:12872
    ds_read_b64_tr_b16 a[56:57], v253 offset:10368
    ds_read_b64_tr_b16 a[58:59], v253 offset:12928
    ds_read_b64_tr_b16 a[60:61], v252 offset:15360
    ds_read_b64_tr_b16 a[62:63], v252 offset:17920
    ds_read_b64_tr_b16 a[64:65], v252 offset:15368
    ds_read_b64_tr_b16 a[66:67], v252 offset:17928
    ds_read_b64_tr_b16 a[68:69], v252 offset:15424
    ds_read_b64_tr_b16 a[70:71], v252 offset:17984
    ds_read_b64_tr_b16 a[72:73], v252 offset:15432
    ds_read_b64_tr_b16 a[74:75], v252 offset:17992
    ds_read_b64_tr_b16 a[76:77], v253 offset:15488
    ds_read_b64_tr_b16 a[78:79], v253 offset:18048
    ds_read_b64_tr_b16 a[80:81], v250 offset:0
    ds_read_b64_tr_b16 a[82:83], v250 offset:2560
    ds_read_b64_tr_b16 a[84:85], v250 offset:8
    ds_read_b64_tr_b16 a[86:87], v250 offset:2568
    ds_read_b64_tr_b16 a[88:89], v250 offset:64
    ds_read_b64_tr_b16 a[90:91], v250 offset:2624
    ds_read_b64_tr_b16 a[92:93], v250 offset:72
    ds_read_b64_tr_b16 a[94:95], v250 offset:2632
    ds_read_b64_tr_b16 a[96:97], v251 offset:128
    ds_read_b64_tr_b16 a[98:99], v251 offset:2688
    s_waitcnt vmcnt(6)
    v_cmp_ne_u64 vcc, s[64:65], v[18:19]
    s_cbranch_vccz L_pok_13
    s_mov_b32 s100, 0
L_poll_14:
    buffer_load_dwordx2 v[18:19], v17, s[36:39], 0 offen sc1
    s_add_u32 s100, s100, 1
    s_cmp_gt_u32 s100, 200000
    s_waitcnt vmcnt(0)
    s_cbranch_scc1 L_pdone_15
    v_cmp_ne_u64 vcc, s[64:65], v[18:19]
    s_cbranch_vccnz L_poll_14
L_pdone_15:
L_pok_13:
    buffer_load_dwordx4 v[80:83], v200, s[36:39], s4 offen sc1
    buffer_load_dwordx4 v[84:87], v200, s[36:39], s5 offen sc1
    buffer_load_dwordx4 v[88:91], v200, s[36:39], s6 offen sc1
    buffer_load_dwordx4 v[92:95], v200, s[36:39], s7 offen sc1
    buffer_load_dwordx4 v[96:99], v200, s[36:39], s95 offen sc1
    buffer_load_dwordx4 v[100:103], v201, s[36:39], s4 offen sc1
    buffer_load_dwordx4 v[104:107], v201, s[36:39], s5 offen sc1
    buffer_load_dwordx4 v[108:111], v201, s[36:39], s6 offen sc1
    buffer_load_dwordx4 v[112:115], v201, s[36:39], s7 offen sc1
    buffer_load_dwordx4 v[116:119], v201, s[36:39], s95 offen sc1
    buffer_load_dwordx4 v[120:123], v202, s[36:39], s4 offen sc1
    s_waitcnt vmcnt(11) lgkmcnt(0)
    s_barrier
    s_cmp_lg_u32 s58, 0
    s_cbranch_scc1 L_nofl_16
    v_mov_b32 v10, s64
    v_mov_b32 v11, s65
    v_mov_b32 v12, 0x2000
    s_mov_b64 exec, 1
    buffer_store_dwordx2 v[10:11], v12, s[36:39], s26 offen sc1
    s_mov_b64 exec, -1
L_nofl_16:
    v_cmp_ne_u64 vcc, s[64:65], v[210:211]
    s_cbranch_vccz L_pok_17
    s_mov_b32 s100, 0
L_poll_18:
    buffer_load_dwordx2 v[210:211], v209, s[36:39], s25 offen sc1
    s_add_u32 s100, s100, 1
    s_cmp_gt_u32 s100, 200000
    s_waitcnt vmcnt(0)
    s_cbranch_scc1 L_pdone_19
    v_cmp_ne_u64 vcc, s[64:65], v[210:211]
    s_cbranch_vccnz L_poll_18
L_pdone_19:
L_pok_17:
    s_waitcnt vmcnt(10)
    v_mfma_f32_16x16x32_bf16 v[160:163], a[0:3], v[80:83], 0
    s_cmp_eq_u32 s60, 0
    s_cselect_b32 s29, 0x80000000, 0
    s_cselect_b32 s86, 0x30000, s62
    v_mfma_f32_16x16x32_bf16 v[164:167], a[4:7], v[80:83], 0
    v_add3_u32 v204, v4, 4, s29
    v_mfma_f32_16x16x32_bf16 v[168:171], a[8:11], v[80:83], 0
    v_add3_u32 v205, v4, 8, s29
    v_add3_u32 v206, v4, 12, s29
    v_mfma_f32_16x16x32_bf16 v[172:175], a[12:15], v[80:83], 0
    v_add3_u32 v207, v4, 16, s29
    v_add_u32 v208, v2, v3
    v_mfma_f32_16x16x32_bf16 v[176:179], a[16:19], v[80:83], 0
    v_lshlrev_b32 v208, 2, v208
    v_subrev_u32 v208, 60, v208
    buffer_load_dwordx4 v[124:127], v202, s[36:39], s5 offen sc1
    s_waitcnt vmcnt(10)
    v_mfma_f32_16x16x32_bf16 v[160:163], a[20:23], v[84:87], v[160:163]
    v_add_u32 v213, 0x2000, v209
    v_add_u32 v20, 0x300000, v20
    v_mfma_f32_16x16x32_bf16 v[164:167], a[24:27], v[84:87], v[164:167]
    v_add_u32 v21, 0x300000, v21
    v_lshrrev_b32 v212, 1, v3
    v_mfma_f32_16x16x32_bf16 v[168:171], a[28:31], v[84:87], v[168:171]
    v_lshlrev_b32 v212, 2, v212
    v_lshl_add_u32 v212, v2, 3, v212
    v_mfma_f32_16x16x32_bf16 v[172:175], a[32:35], v[84:87], v[172:175]
    s_lshl_b32 s21, s56, 12
    s_add_u32 s21, s21, 0x1c00000
    v_mfma_f32_16x16x32_bf16 v[176:179], a[36:39], v[84:87], v[176:179]
    s_lshl_b32 s28, s57, 9
    s_add_u32 s28, s28, s21
    buffer_load_dwordx4 v[128:131], v202, s[36:39], s6 offen sc1
    s_waitcnt vmcnt(10)
    v_mfma_f32_16x16x32_bf16 v[160:163], a[40:43], v[88:91], v[160:163]
    s_lshl_b32 s70, s69, 7
    s_add_u32 s28, s28, s70
    v_mfma_f32_16x16x32_bf16 v[164:167], a[44:47], v[88:91], v[164:167]
    s_lshl_b32 s22, s59, 12
    s_add_u32 s29, s29, s22
    v_mfma_f32_16x16x32_bf16 v[168:171], a[48:51], v[88:91], v[168:171]
    s_add_u32 s29, s29, 0x1300000
    s_add_u32 s22, s22, 0x1900000
    v_mfma_f32_16x16x32_bf16 v[172:175], a[52:55], v[88:91], v[172:175]
    s_lshl_b32 s70, s57, 2
    s_add_u32 s70, s70, s58
    v_mfma_f32_16x16x32_bf16 v[176:179], a[56:59], v[88:91], v[176:179]
    s_mul_i32 s73, s70, 196608
    s_mul_i32 s12, s89, 65536
    buffer_load_dwordx4 v[132:135], v202, s[36:39], s7 offen sc1
    s_waitcnt vmcnt(10)
    v_mfma_f32_16x16x32_bf16 v[160:163], a[60:63], v[92:95], v[160:163]
    s_sub_u32 s12, s12, s73
    s_cmp_eq_u32 s58, 3
    s_cselect_b32 s12, 0x80000000, s12
    v_mfma_f32_16x16x32_bf16 v[164:167], a[64:67], v[92:95], v[164:167]
    s_add_u32 s73, s73, 0x600000
    v_mfma_f32_16x16x32_bf16 v[168:171], a[68:71], v[92:95], v[168:171]
    s_lshl_b32 s71, s91, 9
    s_xor_b32 s72, s71, 0
    v_mfma_f32_16x16x32_bf16 v[172:175], a[72:75], v[92:95], v[172:175]
    s_add_u32 s8, s72, s73
    s_xor_b32 s72, s71, 256
    v_mfma_f32_16x16x32_bf16 v[176:179], a[76:79], v[92:95], v[176:179]
    s_add_u32 s9, s72, s73
    s_xor_b32 s72, s71, 512
    buffer_load_dwordx4 v[136:139], v202, s[36:39], s95 offen sc1
    s_waitcnt vmcnt(10)
    v_mfma_f32_16x16x32_bf16 v[160:163], a[80:83], v[96:99], v[160:163]
    s_add_u32 s10, s72, s73
    s_xor_b32 s72, s71, 768
    v_mfma_f32_16x16x32_bf16 v[164:167], a[84:87], v[96:99], v[164:167]
    s_add_u32 s11, s72, s73
    s_bitcmp1_b32 s59, 0
    s_cselect_b32 s70, 16, 0
    v_mfma_f32_16x16x32_bf16 v[168:171], a[88:91], v[96:99], v[168:171]
    s_lshr_b32 s90, s90, s70
    v_mfma_f32_16x16x32_bf16 v[172:175], a[92:95], v[96:99], v[172:175]
    s_and_b32 s90, s90, 0xffff
    s_mul_i32 s20, s58, 655360
    v_mfma_f32_16x16x32_bf16 v[176:179], a[96:99], v[96:99], v[176:179]
    s_add_u32 s20, s20, 0x300000
    s_mul_i32 s71, s58, 14
    buffer_load_dwordx4 v[140:143], v203, s[36:39], s4 offen sc1
    s_waitcnt vmcnt(10)
    v_mfma_f32_16x16x32_bf16 v[180:183], a[0:3], v[100:103], 0
    s_cmp_eq_u32 s58, 3
    s_cselect_b32 s71, 41, s71
    v_mfma_f32_16x16x32_bf16 v[184:187], a[4:7], v[100:103], 0
    s_mul_i32 s13, s71, 5120
    s_mul_i32 s72, s57, 286720
    v_mfma_f32_16x16x32_bf16 v[188:191], a[8:11], v[100:103], 0
    s_add_u32 s13, s13, s72
    s_add_u32 s13, s13, 0x1000000
    v_mfma_f32_16x16x32_bf16 v[192:195], a[12:15], v[100:103], 0
    s_mul_i32 s71, s71, 131072
    s_add_u32 s71, s71, 0x600000
    v_mfma_f32_16x16x32_bf16 v[196:199], a[16:19], v[100:103], 0
    ds_write_b128 v5, v[160:163] offset:0
    buffer_load_dwordx4 v[144:147], v203, s[36:39], s5 offen sc1
    s_waitcnt vmcnt(10)
    v_mfma_f32_16x16x32_bf16 v[180:183], a[20:23], v[104:107], v[180:183]
    ds_write_b128 v5, v[164:167] offset:1024
    v_mfma_f32_16x16x32_bf16 v[184:187], a[24:27], v[104:107], v[184:187]
    ds_write_b128 v5, v[168:171] offset:2048
    v_mfma_f32_16x16x32_bf16 v[188:191], a[28:31], v[104:107], v[188:191]
    ds_write_b128 v5, v[172:175] offset:3072
    v_mfma_f32_16x16x32_bf16 v[192:195], a[32:35], v[104:107], v[192:195]
    ds_write_b128 v5, v[176:179] offset:4096
    v_mfma_f32_16x16x32_bf16 v[196:199], a[36:39], v[104:107], v[196:199]
    s_lshl_b32 s72, s66, 8
    s_add_u32 s15, s72, s71
    buffer_load_dwordx4 v[148:151], v203, s[36:39], s6 offen sc1
    s_waitcnt vmcnt(10)
    v_mfma_f32_16x16x32_bf16 v[180:183], a[40:43], v[108:111], v[180:183]
    s_lshl_b32 s72, s67, 8
    s_add_u32 s16, s72, s71
    v_mfma_f32_16x16x32_bf16 v[184:187], a[44:47], v[108:111], v[184:187]
    s_lshl_b32 s72, s68, 8
    s_add_u32 s17, s72, s71
    v_mfma_f32_16x16x32_bf16 v[188:191], a[48:51], v[108:111], v[188:191]
    s_lshl_b32 s72, s69, 8
    s_add_u32 s18, s72, s71
    v_mfma_f32_16x16x32_bf16 v[192:195], a[52:55], v[108:111], v[192:195]
    s_cmp_ge_u32 s58, 2
    s_cselect_b32 s14, 0x80000000, s13
    s_cselect_b32 s19, 0x80000000, 0
    v_mfma_f32_16x16x32_bf16 v[196:199], a[56:59], v[108:111], v[196:199]
    s_add_u32 s19, s19, 1703936
    buffer_load_dwordx4 v[152:155], v203, s[36:39], s7 offen sc1
    s_waitcnt vmcnt(10)
    v_mfma_f32_16x16x32_bf16 v[180:183], a[60:63], v[112:115], v[180:183]
    s_mul_i32 s70, s57, 80
    s_sub_u32 s70, s59, s70
    v_mfma_f32_16x16x32_bf16 v[184:187], a[64:67], v[112:115], v[184:187]
    s_lshr_b32 s71, s70, 3
    s_lshl_b32 s71, s71, 7
    v_mfma_f32_16x16x32_bf16 v[188:191], a[68:71], v[112:115], v[188:191]
    s_and_b32 s70, s70, 7
    s_lshl_b32 s70, s70, 3
    v_mfma_f32_16x16x32_bf16 v[192:195], a[72:75], v[112:115], v[192:195]
    s_add_u32 s70, s70, s71
    s_lshl_b32 s26, s57, 11
    v_mfma_f32_16x16x32_bf16 v[196:199], a[76:79], v[112:115], v[196:199]
    s_add_u32 s26, s26, 0x1d08000
    s_add_u32 s27, s70, s26
    buffer_load_dwordx4 v[156:159], v203, s[36:39], s95 offen sc1
    s_waitcnt vmcnt(10)
    v_mfma_f32_16x16x32_bf16 v[180:183], a[80:83], v[116:119], v[180:183]
    s_mul_i32 s23, s96, 1280
    s_mul_i32 s70, s57, 160
    buffer_load_dword v47, v208, s[40:43], 0 offen
    v_mfma_f32_16x16x32_bf16 v[184:187], a[84:87], v[116:119], v[184:187]
    s_add_u32 s23, s23, s70
    v_mfma_f32_16x16x32_bf16 v[188:191], a[88:91], v[116:119], v[188:191]
    s_add_u32 m0, s86, 64
    s_nop 0
    buffer_load_dwordx4 v204, s[40:43], 0 offen offset:0 lds
    v_mfma_f32_16x16x32_bf16 v[192:195], a[92:95], v[116:119], v[192:195]
    v_mfma_f32_16x16x32_bf16 v[196:199], a[96:99], v[116:119], v[196:199]
    s_waitcnt vmcnt(11)
    v_mfma_f32_16x16x32_bf16 v[160:163], a[0:3], v[120:123], 0
    buffer_load_dwordx4 v204, s[40:43], 0 offen offset:1024 lds
    v_mfma_f32_16x16x32_bf16 v[164:167], a[4:7], v[120:123], 0
    v_mfma_f32_16x16x32_bf16 v[168:171], a[8:11], v[120:123], 0
    v_mfma_f32_16x16x32_bf16 v[172:175], a[12:15], v[120:123], 0
    buffer_load_dwordx4 v204, s[40:43], 0 offen offset:2048 lds
    v_mfma_f32_16x16x32_bf16 v[176:179], a[16:19], v[120:123], 0
    ds_write_b128 v5, v[180:183] offset:5120
    s_waitcnt vmcnt(12)
    v_mfma_f32_16x16x32_bf16 v[160:163], a[20:23], v[124:127], v[160:163]
    buffer_load_dwordx4 v204, s[40:43], 0 offen offset:3072 lds
    ds_write_b128 v5, v[184:187] offset:6144
    v_mfma_f32_16x16x32_bf16 v[164:167], a[24:27], v[124:127], v[164:167]
    ds_write_b128 v5, v[188:191] offset:7168
    v_mfma_f32_16x16x32_bf16 v[168:171], a[28:31], v[124:127], v[168:171]
    ds_write_b128 v5, v[192:195] offset:8192
    v_mfma_f32_16x16x32_bf16 v[172:175], a[32:35], v[124:127], v[172:175]
    s_add_u32 m0, s86, 4224
    s_nop 0
    buffer_load_dwordx4 v205, s[40:43], 0 offen offset:0 lds
    ds_write_b128 v5, v[196:199] offset:9216
    v_mfma_f32_16x16x32_bf16 v[176:179], a[36:39], v[124:127], v[176:179]
    s_waitcnt vmcnt(13)
    v_mfma_f32_16x16x32_bf16 v[160:163], a[40:43], v[128:131], v[160:163]
    v_mfma_f32_16x16x32_bf16 v[164:167], a[44:47], v[128:131], v[164:167]
    buffer_load_dwordx4 v205, s[40:43], 0 offen offset:1024 lds
    v_mfma_f32_16x16x32_bf16 v[168:171], a[48:51], v[128:131], v[168:171]
    v_mfma_f32_16x16x32_bf16 v[172:175], a[52:55], v[128:131], v[172:175]
    v_mfma_f32_16x16x32_bf16 v[176:179], a[56:59], v[128:131], v[176:179]
    buffer_load_dwordx4 v205, s[40:43], 0 offen offset:2048 lds
    s_waitcnt vmcnt(14)
    v_mfma_f32_16x16x32_bf16 v[160:163], a[60:63], v[132:135], v[160:163]
    v_mfma_f32_16x16x32_bf16 v[164:167], a[64:67], v[132:135], v[164:167]
    v_mfma_f32_16x16x32_bf16 v[168:171], a[68:71], v[132:135], v[168:171]
    buffer_load_dwordx4 v205, s[40:43], 0 offen offset:3072 lds
    v_mfma_f32_16x16x32_bf16 v[172:175], a[72:75], v[132:135], v[172:175]
    v_mfma_f32_16x16x32_bf16 v[176:179], a[76:79], v[132:135], v[176:179]
    s_waitcnt vmcnt(14)
    v_mfma_f32_16x16x32_bf16 v[160:163], a[80:83], v[136:139], v[160:163]
    s_add_u32 m0, s86, 8384
    s_nop 0
    buffer_load_dwordx4 v206, s[40:43], 0 offen offset:0 lds
    v_mfma_f32_16x16x32_bf16 v[164:167], a[84:87], v[136:139], v[164:167]
    v_mfma_f32_16x16x32_bf16 v[168:171], a[88:91], v[136:139], v[168:171]
    buffer_load_dwordx4 v206, s[40:43], 0 offen offset:1024 lds
    v_mfma_f32_16x16x32_bf16 v[172:175], a[92:95], v[136:139], v[172:175]
    v_mfma_f32_16x16x32_bf16 v[176:179], a[96:99], v[136:139], v[176:179]
    s_waitcnt vmcnt(15)
    v_mfma_f32_16x16x32_bf16 v[180:183], a[0:3], v[140:143], v[220:223]
    buffer_load_dwordx4 v206, s[40:43], 0 offen offset:2048 lds
    v_mfma_f32_16x16x32_bf16 v[184:187], a[4:7], v[140:143], v[224:227]
    v_mfma_f32_16x16x32_bf16 v[188:191], a[8:11], v[140:143], v[228:231]
    v_mfma_f32_16x16x32_bf16 v[192:195], a[12:15], v[140:143], v[232:235]
    buffer_load_dwordx4 v206, s[40:43], 0 offen offset:3072 lds
    v_mfma_f32_16x16x32_bf16 v[196:199], a[16:19], v[140:143], v[236:239]
    ds_write_b128 v5, v[160:163] offset:10240
    s_waitcnt vmcnt(16)
    v_mfma_f32_16x16x32_bf16 v[180:183], a[20:23], v[144:147], v[180:183]
    ds_write_b128 v5, v[164:167] offset:11264
    v_mfma_f32_16x16x32_bf16 v[184:187], a[24:27], v[144:147], v[184:187]
    s_add_u32 m0, s86, 12544
    s_nop 0
    buffer_load_dwordx4 v207, s[40:43], 0 offen offset:0 lds
    ds_write_b128 v5, v[168:171] offset:12288
    v_mfma_f32_16x16x32_bf16 v[188:191], a[28:31], v[144:147], v[188:191]
    ds_write_b128 v5, v[172:175] offset:13312
    v_mfma_f32_16x16x32_bf16 v[192:195], a[32:35], v[144:147], v[192:195]
    ds_write_b128 v5, v[176:179] offset:14336
    v_mfma_f32_16x16x32_bf16 v[196:199], a[36:39], v[144:147], v[196:199]
    buffer_load_dwordx4 v207, s[40:43], 0 offen offset:1024 lds
    s_waitcnt lgkmcnt(0)
    s_barrier
    buffer_load_dwordx4 v207, s[40:43], 0 offen offset:2048 lds
    buffer_load_dwordx4 v207, s[40:43], 0 offen offset:3072 lds
    buffer_load_dwordx2 v[18:19], v213, s[36:39], s25 offen sc1
    s_waitcnt vmcnt(20)
    v_mfma_f32_16x16x32_bf16 v[180:183], a[40:43], v[148:151], v[180:183]
    ds_read_b128 v[80:83], v6 offset:0
    v_mfma_f32_16x16x32_bf16 v[184:187], a[44:47], v[148:151], v[184:187]
    ds_read_b128 v[84:87], v6 offset:1024
    v_mfma_f32_16x16x32_bf16 v[188:191], a[48:51], v[148:151], v[188:191]
    ds_read_b128 v[88:91], v6 offset:2048
    v_mfma_f32_16x16x32_bf16 v[192:195], a[52:55], v[148:151], v[192:195]
    ds_read_b128 v[92:95], v6 offset:3072
    v_mfma_f32_16x16x32_bf16 v[196:199], a[56:59], v[148:151], v[196:199]
    s_add_u32 s48, s87, 0
    buffer_load_dwordx4 a[100:103], v4, s[36:39], s48 offen offset:0 sc1
    ds_read_b128 v[96:99], v6 offset:4096
    s_waitcnt vmcnt(20)
    v_mfma_f32_16x16x32_bf16 v[180:183], a[60:63], v[152:155], v[180:183]
    ds_read_b128 v[100:103], v7 offset:0
    v_mfma_f32_16x16x32_bf16 v[184:187], a[64:67], v[152:155], v[184:187]
    ds_read_b128 v[104:107], v7 offset:1024
    v_mfma_f32_16x16x32_bf16 v[188:191], a[68:71], v[152:155], v[188:191]
    ds_read_b128 v[108:111], v7 offset:2048
    v_mfma_f32_16x16x32_bf16 v[192:195], a[72:75], v[152:155], v[192:195]
    ds_read_b128 v[112:115], v7 offset:3072
    v_mfma_f32_16x16x32_bf16 v[196:199], a[76:79], v[152:155], v[196:199]
    s_add_u32 s49, s87, 20480
    buffer_load_dwordx4 a[104:107], v4, s[36:39], s49 offen offset:0 sc1
    ds_read_b128 v[116:119], v7 offset:4096
    s_waitcnt vmcnt(20)
    v_mfma_f32_16x16x32_bf16 v[180:183], a[80:83], v[156:159], v[180:183]
    ds_read_b128 v[120:123], v8 offset:0
    v_mfma_f32_16x16x32_bf16 v[184:187], a[84:87], v[156:159], v[184:187]
    ds_read_b128 v[124:127], v8 offset:1024
    v_mfma_f32_16x16x32_bf16 v[188:191], a[88:91], v[156:159], v[188:191]
    ds_read_b128 v[128:131], v8 offset:2048
    v_mfma_f32_16x16x32_bf16 v[192:195], a[92:95], v[156:159], v[192:195]
    ds_read_b128 v[132:135], v8 offset:3072
    v_mfma_f32_16x16x32_bf16 v[196:199], a[96:99], v[156:159], v[196:199]
    buffer_load_dwordx4 a[108:111], v4, s[36:39], s48 offen offset:1024 sc1
    ds_read_b128 v[136:139], v8 offset:4096
    s_waitcnt lgkmcnt(0)
    v_pk_add_f32 v[80:81], v[80:81], v[100:101]
    v_pk_add_f32 v[82:83], v[82:83], v[102:103]
    v_pk_add_f32 v[84:85], v[84:85], v[104:105]
    v_pk_add_f32 v[86:87], v[86:87], v[106:107]
    v_pk_add_f32 v[88:89], v[88:89], v[108:109]
    v_pk_add_f32 v[90:91], v[90:91], v[110:111]
    v_pk_add_f32 v[92:93], v[92:93], v[112:113]
    v_pk_add_f32 v[94:95], v[94:95], v[114:115]
    v_pk_add_f32 v[96:97], v[96:97], v[116:117]
    v_pk_add_f32 v[98:99], v[98:99], v[118:119]
    v_pk_add_f32 v[80:81], v[80:81], v[120:121]
    v_pk_add_f32 v[82:83], v[82:83], v[122:123]
    v_pk_add_f32 v[84:85], v[84:85], v[124:125]
    v_pk_add_f32 v[86:87], v[86:87], v[126:127]
    v_pk_add_f32 v[88:89], v[88:89], v[128:129]
    v_pk_add_f32 v[90:91], v[90:91], v[130:131]
    v_pk_add_f32 v[92:93], v[92:93], v[132:133]
    v_pk_add_f32 v[94:95], v[94:95], v[134:135]
    buffer_load_dwordx4 a[112:115], v4, s[36:39], s49 offen offset:1024 sc1
    v_pk_add_f32 v[96:97], v[96:97], v[136:137]
    v_pk_add_f32 v[98:99], v[98:99], v[138:139]
    v_pk_add_f32 v[180:181], v[180:181], v[80:81]
    v_pk_add_f32 v[182:183], v[182:183], v[82:83]
    v_pk_add_f32 v[184:185], v[184:185], v[84:85]
    v_pk_add_f32 v[186:187], v[186:187], v[86:87]
    v_pk_add_f32 v[188:189], v[188:189], v[88:89]
    v_pk_add_f32 v[190:191], v[190:191], v[90:91]
    v_pk_add_f32 v[192:193], v[192:193], v[92:93]
    v_pk_add_f32 v[194:195], v[194:195], v[94:95]
    v_pk_add_f32 v[196:197], v[196:197], v[96:97]
    v_pk_add_f32 v[198:199], v[198:199], v[98:99]
    v_cvt_pk_bf16_f32 v34, v180, v181
    v_cvt_pk_bf16_f32 v35, v182, v183
    v_cvt_pk_bf16_f32 v36, v184, v185
    v_cvt_pk_bf16_f32 v37, v186, v187
    v_cvt_pk_bf16_f32 v38, v188, v189
    v_cvt_pk_bf16_f32 v39, v190, v191
    v_cvt_pk_bf16_f32 v40, v192, v193
    v_cvt_pk_bf16_f32 v41, v194, v195
    v_cvt_pk_bf16_f32 v42, v196, v197
    v_cvt_pk_bf16_f32 v43, v198, v199
    buffer_store_dwordx4 v[34:37], v20, s[36:39], 0 offen sc1
    buffer_store_dwordx4 v[38:41], v20, s[36:39], s30 offen sc1
    buffer_store_dwordx2 v[42:43], v21, s[36:39], s31 offen sc1
    v_mov_b32 v9, 0x3f803f80
    v_dot2_f32_bf16 v80, v34, v9, 0
    v_dot2_f32_bf16 v81, v34, v34, 0
    v_dot2_f32_bf16 v80, v35, v9, v80
    v_dot2_f32_bf16 v81, v35, v35, v81
    v_dot2_f32_bf16 v80, v36, v9, v80
    v_dot2_f32_bf16 v81, v36, v36, v81
    v_dot2_f32_bf16 v80, v37, v9, v80
    v_dot2_f32_bf16 v81, v37, v37, v81
    v_dot2_f32_bf16 v80, v38, v9, v80
    v_dot2_f32_bf16 v81, v38, v38, v81
    v_dot2_f32_bf16 v80, v39, v9, v80
    v_dot2_f32_bf16 v81, v39, v39, v81
    v_dot2_f32_bf16 v80, v40, v9, v80
    v_dot2_f32_bf16 v81, v40, v40, v81
    v_dot2_f32_bf16 v80, v41, v9, v80
    v_dot2_f32_bf16 v81, v41, v41, v81
    v_dot2_f32_bf16 v80, v42, v9, v80
    v_dot2_f32_bf16 v81, v42, v42, v81
    v_dot2_f32_bf16 v80, v43, v9, v80
    v_dot2_f32_bf16 v81, v43, v43, v81
    s_nop 2
    v_permlane32_swap_b32 v80, v81
    v_add_f32 v80, v80, v81
    v_mov_b32 v81, v80
    s_nop 1
    v_permlane16_swap_b32 v80, v81
    v_add_f32 v80, v80, v81
    s_mov_b32 exec_lo, 0xffff
    s_mov_b32 exec_hi, 0xffff
    buffer_store_dword v80, v212, s[36:39], s28 offen sc1
    s_mov_b64 exec, -1
    s_waitcnt vmcnt(8)
    v_cmp_ne_u64 vcc, s[64:65], v[18:19]
    s_cbranch_vccz L_pok_20
    s_mov_b32 s100, 0
L_poll_21:
    buffer_load_dwordx2 v[18:19], v213, s[36:39], s25 offen sc1
    s_add_u32 s100, s100, 1
    s_cmp_gt_u32 s100, 200000
    s_waitcnt vmcnt(0)
    s_cbranch_scc1 L_pdone_22
    v_cmp_ne_u64 vcc, s[64:65], v[18:19]
    s_cbranch_vccnz L_poll_21
L_pdone_22:
L_pok_20:
    s_add_u32 m0, s86, 16640
    s_nop 0
    buffer_load_dwordx4 v4, s[36:39], s29 offen offset:0 sc1 lds
    buffer_load_dwordx4 v4, s[36:39], s29 offen offset:1024 sc1 lds
    buffer_load_dwordx4 v4, s[36:39], s29 offen offset:2048 sc1 lds
    buffer_load_dwordx4 v4, s[36:39], s29 offen offset:3072 sc1 lds
    s_add_u32 s29, s29, 2621440
    s_add_u32 m0, s86, 20768
    s_nop 0
    buffer_load_dwordx4 v4, s[36:39], s29 offen offset:0 sc1 lds
    buffer_load_dwordx4 v4, s[36:39], s29 offen offset:1024 sc1 lds
    buffer_load_dwordx4 v4, s[36:39], s29 offen offset:2048 sc1 lds
    buffer_load_dwordx4 v4, s[36:39], s29 offen offset:3072 sc1 lds
    buffer_load_dwordx4 a[116:119], v4, s[36:39], s48 offen offset:2048 sc1
    buffer_load_dwordx4 a[120:123], v4, s[36:39], s49 offen offset:2048 sc1
    buffer_load_dwordx4 a[124:127], v4, s[36:39], s48 offen offset:3072 sc1
    buffer_load_dwordx4 a[128:131], v4, s[36:39], s49 offen offset:3072 sc1
    s_cmp_eq_u32 s60, 0
    s_cbranch_scc1 L_alt_23
    v_and_b32 v17, 3, v2
    v_mul_u32_u24 v13, 4160, v17
    v_lshrrev_b32 v17, 2, v2
    v_add_u32 v17, v17, v3
    v_lshl_add_u32 v13, v17, 4, v13
    s_add_u32 s70, s62, 0
    v_add_u32 v13, s70, v13
    v_and_b32 v17, 1, v2
    v_mul_u32_u24 v17, 4128, v17
    s_add_u32 s70, s62, 16640
    v_add_u32 v17, s70, v17
    v_add_u32 v16, 4096, v17
    v_lshrrev_b32 v18, 1, v2
    v_lshlrev_b32 v18, 6, v18
    v_sub_u32 v17, v17, v18
    v_lshl_add_u32 v17, v3, 4, v17
    v_add_u32 v14, 448, v17
    v_add_u32 v15, 3584, v14
    v_min_u32 v15, v15, v16
    s_add_u32 s48, s87, 4096
    buffer_load_dwordx4 a[132:135], v4, s[36:39], s48 offen offset:0 sc1
    v_mul_u32_u24 v17, 4160, v3
    v_lshl_add_u32 v17, v2, 2, v17
    v_add_u32 v17, s62, v17
    ds_write_b32 v17, v47
    v_mov_b32 v144, 0
    v_mov_b32 v145, 0
    v_mov_b32 v146, 0
    v_mov_b32 v147, 0
    s_mov_b64 exec, 3
    ds_write_b128 v16, v[144:147]
    s_mov_b64 exec, -1
    v_lshrrev_b32 v17, 2, v2
    v_add_u32 v17, v17, v3
    v_mov_b32 v18, s90
    v_cmp_eq_u32 vcc, 3, v17
    v_and_b32 v17, 3, v2
    s_nop 0
    v_cndmask_b32 v18, 0, v18, vcc
    v_cmp_eq_u32 vcc, 3, v17
    s_nop 1
    v_cndmask_b32 v144, 0, v18, vcc
    s_add_u32 s49, s87, 24576
    buffer_load_dwordx4 a[136:139], v4, s[36:39], s49 offen offset:0 sc1
    v_cmp_eq_u32 vcc, 2, v17
    s_nop 1
    v_cndmask_b32 v145, 0, v18, vcc
    v_cmp_eq_u32 vcc, 1, v17
    s_nop 1
    v_cndmask_b32 v146, 0, v18, vcc
    v_cmp_eq_u32 vcc, 0, v17
    s_nop 1
    v_cndmask_b32 v147, 0, v18, vcc
    s_waitcnt vmcnt(14)
    s_barrier
    s_cmp_lg_u32 s58, 0
    s_cbranch_scc1 L_nofl_25
    v_mov_b32 v10, s64
    v_mov_b32 v11, s65
    v_mov_b32 v12, 0x1000
    s_mov_b64 exec, 1
    buffer_store_dwordx2 v[10:11], v12, s[36:39], s24 offen sc1
    s_mov_b64 exec, -1
L_nofl_25:
    s_waitcnt vmcnt(6)
    ds_read_b128 v[140:143], v14 offset:0
    ds_read_b128 v[136:139], v14 offset:512
    ds_read_b128 v[132:135], v14 offset:1024
    ds_read_b128 v[128:131], v14 offset:1536
    ds_read_b128 v[124:127], v14 offset:2048
    ds_read_b128 v[120:123], v14 offset:2560
    ds_read_b128 v[116:119], v14 offset:3072
    ds_read_b128 v[112:115], v15
    ds_read_b128 v[108:111], v13 offset:3584
    ds_read_b128 v[104:107], v13 offset:3072
    ds_read_b128 v[100:103], v13 offset:2560
    buffer_load_dwordx4 a[140:143], v4, s[36:39], s48 offen offset:1024 sc1
    ds_read_b128 v[96:99], v13 offset:2048
    ds_read_b128 v[92:95], v13 offset:1536
    ds_read_b128 v[88:91], v13 offset:1024
    ds_read_b128 v[84:87], v13 offset:512
    ds_read_b128 v[80:83], v13 offset:0
    s_waitcnt lgkmcnt(15)
    v_mfma_f32_16x16x32_bf16 v[76:79], v[144:147], v[140:143], 0
    s_waitcnt lgkmcnt(14)
    v_mfma_f32_16x16x32_bf16 v[72:75], v[144:147], v[136:139], 0
    s_waitcnt lgkmcnt(13)
    v_mfma_f32_16x16x32_bf16 v[68:71], v[144:147], v[132:135], 0
    buffer_load_dwordx4 a[144:147], v4, s[36:39], s49 offen offset:1024 sc1
    s_waitcnt lgkmcnt(12)
    v_mfma_f32_16x16x32_bf16 v[64:67], v[144:147], v[128:131], 0
    s_waitcnt lgkmcnt(11)
    v_mfma_f32_16x16x32_bf16 v[60:63], v[144:147], v[124:127], 0
    s_waitcnt lgkmcnt(10)
    v_mfma_f32_16x16x32_bf16 v[56:59], v[144:147], v[120:123], 0
    s_waitcnt lgkmcnt(9)
    v_mfma_f32_16x16x32_bf16 v[52:55], v[144:147], v[116:119], 0
    s_waitcnt lgkmcnt(8)
    v_mfma_f32_16x16x32_bf16 v[48:51], v[144:147], v[112:115], 0
    buffer_load_dwordx4 a[148:151], v4, s[36:39], s48 offen offset:2048 sc1
    s_waitcnt lgkmcnt(0)
    v_mfma_f32_16x16x32_bf16 v[76:79], v[92:95], v[128:131], v[76:79]
    v_add_u32 v15, 3648, v14
    v_mfma_f32_16x16x32_bf16 v[76:79], v[96:99], v[124:127], v[76:79]
    v_min_u32 v15, v15, v16
    v_mfma_f32_16x16x32_bf16 v[76:79], v[88:91], v[132:135], v[76:79]
    v_mfma_f32_16x16x32_bf16 v[76:79], v[100:103], v[120:123], v[76:79]
    buffer_load_dwordx4 a[152:155], v4, s[36:39], s49 offen offset:2048 sc1
    v_mfma_f32_16x16x32_bf16 v[76:79], v[84:87], v[136:139], v[76:79]
    v_mfma_f32_16x16x32_bf16 v[76:79], v[104:107], v[116:119], v[76:79]
    v_mfma_f32_16x16x32_bf16 v[76:79], v[80:83], v[140:143], v[76:79]
    v_mfma_f32_16x16x32_bf16 v[76:79], v[108:111], v[112:115], v[76:79]
    buffer_load_dwordx4 a[156:159], v4, s[36:39], s48 offen offset:3072 sc1
    ds_read_b128 v[108:111], v13 offset:3648
    ds_read_b128 v[140:143], v14 offset:64
    v_mfma_f32_16x16x32_bf16 v[72:75], v[80:83], v[136:139], v[72:75]
    v_mfma_f32_16x16x32_bf16 v[72:75], v[84:87], v[132:135], v[72:75]
    v_mfma_f32_16x16x32_bf16 v[72:75], v[88:91], v[128:131], v[72:75]
    v_mfma_f32_16x16x32_bf16 v[72:75], v[92:95], v[124:127], v[72:75]
    buffer_load_dwordx4 a[160:163], v4, s[36:39], s49 offen offset:3072 sc1
    v_mfma_f32_16x16x32_bf16 v[72:75], v[96:99], v[120:123], v[72:75]
    v_mfma_f32_16x16x32_bf16 v[72:75], v[100:103], v[116:119], v[72:75]
    v_mfma_f32_16x16x32_bf16 v[72:75], v[104:107], v[112:115], v[72:75]
    ds_read_b128 v[104:107], v13 offset:3136
    ds_read_b128 v[136:139], v14 offset:576
    v_mfma_f32_16x16x32_bf16 v[68:71], v[80:83], v[132:135], v[68:71]
    v_mfma_f32_16x16x32_bf16 v[68:71], v[84:87], v[128:131], v[68:71]
    s_add_u32 s48, s87, 8192
    buffer_load_dwordx4 a[164:167], v4, s[36:39], s48 offen offset:0 sc1
    v_mfma_f32_16x16x32_bf16 v[68:71], v[88:91], v[124:127], v[68:71]
    v_mfma_f32_16x16x32_bf16 v[68:71], v[92:95], v[120:123], v[68:71]
    v_mfma_f32_16x16x32_bf16 v[68:71], v[96:99], v[116:119], v[68:71]
    v_mfma_f32_16x16x32_bf16 v[68:71], v[100:103], v[112:115], v[68:71]
    s_add_u32 s49, s87, 28672
    buffer_load_dwordx4 a[168:171], v4, s[36:39], s49 offen offset:0 sc1
    ds_read_b128 v[100:103], v13 offset:2624
    ds_read_b128 v[132:135], v14 offset:1088
    v_mfma_f32_16x16x32_bf16 v[64:67], v[80:83], v[128:131], v[64:67]
    v_mfma_f32_16x16x32_bf16 v[64:67], v[84:87], v[124:127], v[64:67]
    v_mfma_f32_16x16x32_bf16 v[64:67], v[88:91], v[120:123], v[64:67]
    v_mfma_f32_16x16x32_bf16 v[64:67], v[92:95], v[116:119], v[64:67]
    buffer_load_dwordx4 a[172:175], v4, s[36:39], s48 offen offset:1024 sc1
    v_mfma_f32_16x16x32_bf16 v[64:67], v[96:99], v[112:115], v[64:67]
    ds_read_b128 v[96:99], v13 offset:2112
    ds_read_b128 v[128:131], v14 offset:1600
    v_mfma_f32_16x16x32_bf16 v[60:63], v[80:83], v[124:127], v[60:63]
    v_mfma_f32_16x16x32_bf16 v[60:63], v[84:87], v[120:123], v[60:63]
    v_mfma_f32_16x16x32_bf16 v[60:63], v[88:91], v[116:119], v[60:63]
    buffer_load_dwordx4 a[176:179], v4, s[36:39], s49 offen offset:1024 sc1
    v_mfma_f32_16x16x32_bf16 v[60:63], v[92:95], v[112:115], v[60:63]
    ds_read_b128 v[92:95], v13 offset:1600
    ds_read_b128 v[124:127], v14 offset:2112
    v_mfma_f32_16x16x32_bf16 v[56:59], v[80:83], v[120:123], v[56:59]
    v_mfma_f32_16x16x32_bf16 v[56:59], v[84:87], v[116:119], v[56:59]
    v_mfma_f32_16x16x32_bf16 v[56:59], v[88:91], v[112:115], v[56:59]
    ds_read_b128 v[88:91], v13 offset:1088
    ds_read_b128 v[120:123], v14 offset:2624
    v_mfma_f32_16x16x32_bf16 v[52:55], v[80:83], v[116:119], v[52:55]
    buffer_load_dwordx4 a[180:183], v4, s[36:39], s48 offen offset:2048 sc1
    v_mfma_f32_16x16x32_bf16 v[52:55], v[84:87], v[112:115], v[52:55]
    ds_read_b128 v[84:87], v13 offset:576
    ds_read_b128 v[116:119], v14 offset:3136
    v_mfma_f32_16x16x32_bf16 v[48:51], v[80:83], v[112:115], v[48:51]
    ds_read_b128 v[80:83], v13 offset:64
    ds_read_b128 v[112:115], v15
    s_waitcnt lgkmcnt(7)
    v_mfma_f32_16x16x32_bf16 v[76:79], v[92:95], v[128:131], v[76:79]
    v_add_u32 v15, 3712, v14
    s_waitcnt lgkmcnt(6)
    v_mfma_f32_16x16x32_bf16 v[76:79], v[96:99], v[124:127], v[76:79]
    buffer_load_dwordx4 a[184:187], v4, s[36:39], s49 offen offset:2048 sc1
    v_min_u32 v15, v15, v16
    s_waitcnt lgkmcnt(5)
    v_mfma_f32_16x16x32_bf16 v[76:79], v[88:91], v[132:135], v[76:79]
    s_waitcnt lgkmcnt(4)
    v_mfma_f32_16x16x32_bf16 v[76:79], v[100:103], v[120:123], v[76:79]
    s_waitcnt lgkmcnt(3)
    v_mfma_f32_16x16x32_bf16 v[76:79], v[84:87], v[136:139], v[76:79]
    s_waitcnt lgkmcnt(2)
    v_mfma_f32_16x16x32_bf16 v[76:79], v[104:107], v[116:119], v[76:79]
    buffer_load_dwordx4 a[188:191], v4, s[36:39], s48 offen offset:3072 sc1
    s_waitcnt lgkmcnt(1)
    v_mfma_f32_16x16x32_bf16 v[76:79], v[80:83], v[140:143], v[76:79]
    s_waitcnt lgkmcnt(0)
    v_mfma_f32_16x16x32_bf16 v[76:79], v[108:111], v[112:115], v[76:79]
    ds_read_b128 v[108:111], v13 offset:3712
    ds_read_b128 v[140:143], v14 offset:128
    v_mfma_f32_16x16x32_bf16 v[72:75], v[80:83], v[136:139], v[72:75]
    v_mfma_f32_16x16x32_bf16 v[72:75], v[84:87], v[132:135], v[72:75]
    buffer_load_dwordx4 a[192:195], v4, s[36:39], s49 offen offset:3072 sc1
    v_mfma_f32_16x16x32_bf16 v[72:75], v[88:91], v[128:131], v[72:75]
    v_mfma_f32_16x16x32_bf16 v[72:75], v[92:95], v[124:127], v[72:75]
    v_mfma_f32_16x16x32_bf16 v[72:75], v[96:99], v[120:123], v[72:75]
    v_mfma_f32_16x16x32_bf16 v[72:75], v[100:103], v[116:119], v[72:75]
    v_mfma_f32_16x16x32_bf16 v[72:75], v[104:107], v[112:115], v[72:75]
    s_add_u32 s48, s87, 12288
    buffer_load_dwordx4 a[196:199], v4, s[36:39], s48 offen offset:0 sc1
    ds_read_b128 v[104:107], v13 offset:3200
    ds_read_b128 v[136:139], v14 offset:640
    v_mfma_f32_16x16x32_bf16 v[68:71], v[80:83], v[132:135], v[68:71]
    v_mfma_f32_16x16x32_bf16 v[68:71], v[84:87], v[128:131], v[68:71]
    v_mfma_f32_16x16x32_bf16 v[68:71], v[88:91], v[124:127], v[68:71]
    v_mfma_f32_16x16x32_bf16 v[68:71], v[92:95], v[120:123], v[68:71]
    s_add_u32 s49, s87, 32768
    buffer_load_dwordx4 a[200:203], v4, s[36:39], s49 offen offset:0 sc1
    v_mfma_f32_16x16x32_bf16 v[68:71], v[96:99], v[116:119], v[68:71]
    v_mfma_f32_16x16x32_bf16 v[68:71], v[100:103], v[112:115], v[68:71]
    ds_read_b128 v[100:103], v13 offset:2688
    ds_read_b128 v[132:135], v14 offset:1152
    v_mfma_f32_16x16x32_bf16 v[64:67], v[80:83], v[128:131], v[64:67]
    v_mfma_f32_16x16x32_bf16 v[64:67], v[84:87], v[124:127], v[64:67]
    buffer_load_dwordx4 a[204:207], v4, s[36:39], s48 offen offset:1024 sc1
    v_mfma_f32_16x16x32_bf16 v[64:67], v[88:91], v[120:123], v[64:67]
    v_mfma_f32_16x16x32_bf16 v[64:67], v[92:95], v[116:119], v[64:67]
    v_mfma_f32_16x16x32_bf16 v[64:67], v[96:99], v[112:115], v[64:67]
    ds_read_b128 v[96:99], v13 offset:2176
    ds_read_b128 v[128:131], v14 offset:1664
    v_mfma_f32_16x16x32_bf16 v[60:63], v[80:83], v[124:127], v[60:63]
    buffer_load_dwordx4 a[208:211], v4, s[36:39], s49 offen offset:1024 sc1
    v_mfma_f32_16x16x32_bf16 v[60:63], v[84:87], v[120:123], v[60:63]
    v_mfma_f32_16x16x32_bf16 v[60:63], v[88:91], v[116:119], v[60:63]
    v_mfma_f32_16x16x32_bf16 v[60:63], v[92:95], v[112:115], v[60:63]
    ds_read_b128 v[92:95], v13 offset:1664
    ds_read_b128 v[124:127], v14 offset:2176
    v_mfma_f32_16x16x32_bf16 v[56:59], v[80:83], v[120:123], v[56:59]
    v_mfma_f32_16x16x32_bf16 v[56:59], v[84:87], v[116:119], v[56:59]
    buffer_load_dwordx4 a[212:215], v4, s[36:39], s48 offen offset:2048 sc1
    v_mfma_f32_16x16x32_bf16 v[56:59], v[88:91], v[112:115], v[56:59]
    ds_read_b128 v[88:91], v13 offset:1152
    ds_read_b128 v[120:123], v14 offset:2688
    v_mfma_f32_16x16x32_bf16 v[52:55], v[80:83], v[116:119], v[52:55]
    v_mfma_f32_16x16x32_bf16 v[52:55], v[84:87], v[112:115], v[52:55]
    ds_read_b128 v[84:87], v13 offset:640
    ds_read_b128 v[116:119], v14 offset:3200
    v_mfma_f32_16x16x32_bf16 v[48:51], v[80:83], v[112:115], v[48:51]
    buffer_load_dwordx4 a[216:219], v4, s[36:39], s49 offen offset:2048 sc1
    ds_read_b128 v[80:83], v13 offset:128
    ds_read_b128 v[112:115], v15
    s_waitcnt lgkmcnt(7)
    v_mfma_f32_16x16x32_bf16 v[76:79], v[92:95], v[128:131], v[76:79]
    s_waitcnt lgkmcnt(6)
    v_mfma_f32_16x16x32_bf16 v[76:79], v[96:99], v[124:127], v[76:79]
    s_waitcnt lgkmcnt(5)
    v_mfma_f32_16x16x32_bf16 v[76:79], v[88:91], v[132:135], v[76:79]
    s_waitcnt lgkmcnt(4)
    v_mfma_f32_16x16x32_bf16 v[76:79], v[100:103], v[120:123], v[76:79]
    buffer_load_dwordx4 a[220:223], v4, s[36:39], s48 offen offset:3072 sc1
    s_waitcnt lgkmcnt(3)
    v_mfma_f32_16x16x32_bf16 v[76:79], v[84:87], v[136:139], v[76:79]
    s_waitcnt lgkmcnt(2)
    v_mfma_f32_16x16x32_bf16 v[76:79], v[104:107], v[116:119], v[76:79]
    s_waitcnt lgkmcnt(1)
    v_mfma_f32_16x16x32_bf16 v[76:79], v[80:83], v[140:143], v[76:79]
    s_waitcnt lgkmcnt(0)
    v_mfma_f32_16x16x32_bf16 v[76:79], v[108:111], v[112:115], v[76:79]
    buffer_load_dwordx4 a[224:227], v4, s[36:39], s49 offen offset:3072 sc1
    v_mfma_f32_16x16x32_bf16 v[72:75], v[80:83], v[136:139], v[72:75]
    v_mfma_f32_16x16x32_bf16 v[72:75], v[84:87], v[132:135], v[72:75]
    v_mfma_f32_16x16x32_bf16 v[72:75], v[88:91], v[128:131], v[72:75]
    v_mfma_f32_16x16x32_bf16 v[72:75], v[92:95], v[124:127], v[72:75]
    v_mfma_f32_16x16x32_bf16 v[72:75], v[96:99], v[120:123], v[72:75]
    s_add_u32 s48, s87, 16384
    buffer_load_dwordx4 a[228:231], v4, s[36:39], s48 offen offset:0 sc1
    v_mfma_f32_16x16x32_bf16 v[72:75], v[100:103], v[116:119], v[72:75]
    v_mfma_f32_16x16x32_bf16 v[72:75], v[104:107], v[112:115], v[72:75]
    v_mfma_f32_16x16x32_bf16 v[68:71], v[80:83], v[132:135], v[68:71]
    v_mfma_f32_16x16x32_bf16 v[68:71], v[84:87], v[128:131], v[68:71]
    s_add_u32 s49, s87, 36864
    buffer_load_dwordx4 a[232:235], v4, s[36:39], s49 offen offset:0 sc1
    v_mfma_f32_16x16x32_bf16 v[68:71], v[88:91], v[124:127], v[68:71]
    v_mfma_f32_16x16x32_bf16 v[68:71], v[92:95], v[120:123], v[68:71]
    v_mfma_f32_16x16x32_bf16 v[68:71], v[96:99], v[116:119], v[68:71]
    v_mfma_f32_16x16x32_bf16 v[68:71], v[100:103], v[112:115], v[68:71]
    buffer_load_dwordx4 a[236:239], v4, s[36:39], s48 offen offset:1024 sc1
    v_mfma_f32_16x16x32_bf16 v[64:67], v[80:83], v[128:131], v[64:67]
    v_mfma_f32_16x16x32_bf16 v[64:67], v[84:87], v[124:127], v[64:67]
    v_mfma_f32_16x16x32_bf16 v[64:67], v[88:91], v[120:123], v[64:67]
    v_mfma_f32_16x16x32_bf16 v[64:67], v[92:95], v[116:119], v[64:67]
    buffer_load_dwordx4 a[240:243], v4, s[36:39], s49 offen offset:1024 sc1
    v_mfma_f32_16x16x32_bf16 v[64:67], v[96:99], v[112:115], v[64:67]
    v_mfma_f32_16x16x32_bf16 v[60:63], v[80:83], v[124:127], v[60:63]
    v_mfma_f32_16x16x32_bf16 v[60:63], v[84:87], v[120:123], v[60:63]
    v_mfma_f32_16x16x32_bf16 v[60:63], v[88:91], v[116:119], v[60:63]
    v_mfma_f32_16x16x32_bf16 v[60:63], v[92:95], v[112:115], v[60:63]
    v_mfma_f32_16x16x32_bf16 v[56:59], v[80:83], v[120:123], v[56:59]
    v_mfma_f32_16x16x32_bf16 v[56:59], v[84:87], v[116:119], v[56:59]
    v_mfma_f32_16x16x32_bf16 v[56:59], v[88:91], v[112:115], v[56:59]
    v_mfma_f32_16x16x32_bf16 v[52:55], v[80:83], v[116:119], v[52:55]
    v_mfma_f32_16x16x32_bf16 v[52:55], v[84:87], v[112:115], v[52:55]
    v_mfma_f32_16x16x32_bf16 v[48:51], v[80:83], v[112:115], v[48:51]
    s_branch L_join_24
L_alt_23:
    s_add_u32 s48, s87, 4096
    buffer_load_dwordx4 a[132:135], v4, s[36:39], s48 offen offset:0 sc1
    s_add_u32 s49, s87, 24576
    buffer_load_dwordx4 a[136:139], v4, s[36:39], s49 offen offset:0 sc1
    s_waitcnt vmcnt(14)
    s_barrier
    s_cmp_lg_u32 s58, 0
    s_cbranch_scc1 L_nofl_26
    v_mov_b32 v10, s64
    v_mov_b32 v11, s65
    v_mov_b32 v12, 0x1000
    s_mov_b64 exec, 1
    buffer_store_dwordx2 v[10:11], v12, s[36:39], s24 offen sc1
    s_mov_b64 exec, -1
L_nofl_26:
    s_waitcnt vmcnt(6)
    s_add_u32 s48, s87, 4096
    buffer_load_dwordx4 a[140:143], v4, s[36:39], s48 offen offset:1024 sc1
    s_add_u32 s49, s87, 24576
    buffer_load_dwordx4 a[144:147], v4, s[36:39], s49 offen offset:1024 sc1
    s_add_u32 s48, s87, 4096
    buffer_load_dwordx4 a[148:151], v4, s[36:39], s48 offen offset:2048 sc1
    s_add_u32 s49, s87, 24576
    buffer_load_dwordx4 a[152:155], v4, s[36:39], s49 offen offset:2048 sc1
    s_add_u32 s48, s87, 4096
    buffer_load_dwordx4 a[156:159], v4, s[36:39], s48 offen offset:3072 sc1
    s_add_u32 s49, s87, 24576
    buffer_load_dwordx4 a[160:163], v4, s[36:39], s49 offen offset:3072 sc1
    s_add_u32 s48, s87, 8192
    buffer_load_dwordx4 a[164:167], v4, s[36:39], s48 offen offset:0 sc1
    s_add_u32 s49, s87, 28672
    buffer_load_dwordx4 a[168:171], v4, s[36:39], s49 offen offset:0 sc1
    s_add_u32 s48, s87, 8192
    buffer_load_dwordx4 a[172:175], v4, s[36:39], s48 offen offset:1024 sc1
    s_add_u32 s49, s87, 28672
    buffer_load_dwordx4 a[176:179], v4, s[36:39], s49 offen offset:1024 sc1
    s_add_u32 s48, s87, 8192
    buffer_load_dwordx4 a[180:183], v4, s[36:39], s48 offen offset:2048 sc1
    s_add_u32 s49, s87, 28672
    buffer_load_dwordx4 a[184:187], v4, s[36:39], s49 offen offset:2048 sc1
    s_add_u32 s48, s87, 8192
    buffer_load_dwordx4 a[188:191], v4, s[36:39], s48 offen offset:3072 sc1
    s_add_u32 s49, s87, 28672
    buffer_load_dwordx4 a[192:195], v4, s[36:39], s49 offen offset:3072 sc1
    s_add_u32 s48, s87, 12288
    buffer_load_dwordx4 a[196:199], v4, s[36:39], s48 offen offset:0 sc1
    s_add_u32 s49, s87, 32768
    buffer_load_dwordx4 a[200:203], v4, s[36:39], s49 offen offset:0 sc1
    s_add_u32 s48, s87, 12288
    buffer_load_dwordx4 a[204:207], v4, s[36:39], s48 offen offset:1024 sc1
    s_add_u32 s49, s87, 32768
    buffer_load_dwordx4 a[208:211], v4, s[36:39], s49 offen offset:1024 sc1
    s_add_u32 s48, s87, 12288
    buffer_load_dwordx4 a[212:215], v4, s[36:39], s48 offen offset:2048 sc1
    s_add_u32 s49, s87, 32768
    buffer_load_dwordx4 a[216:219], v4, s[36:39], s49 offen offset:2048 sc1
    s_add_u32 s48, s87, 12288
    buffer_load_dwordx4 a[220:223], v4, s[36:39], s48 offen offset:3072 sc1
    s_add_u32 s49, s87, 32768
    buffer_load_dwordx4 a[224:227], v4, s[36:39], s49 offen offset:3072 sc1
    s_add_u32 s48, s87, 16384
    buffer_load_dwordx4 a[228:231], v4, s[36:39], s48 offen offset:0 sc1
    s_add_u32 s49, s87, 36864
    buffer_load_dwordx4 a[232:235], v4, s[36:39], s49 offen offset:0 sc1
    s_add_u32 s48, s87, 16384
    buffer_load_dwordx4 a[236:239], v4, s[36:39], s48 offen offset:1024 sc1
    s_add_u32 s49, s87, 36864
    buffer_load_dwordx4 a[240:243], v4, s[36:39], s49 offen offset:1024 sc1
    s_cmp_lg_u32 s58, 3
    s_cbranch_scc1 L_nw3_27
    s_lshl_b32 s44, s56, 7
    s_add_u32 s44, s44, 0x1d01000
    v_lshlrev_b32 v9, 3, v1
    s_mov_b32 s100, 0
    s_mov_b64 exec, 0xff
L_poll_28:
    buffer_load_dwordx2 v[10:11], v9, s[36:39], s44 offen sc1
    s_add_u32 s100, s100, 1
    s_cmp_gt_u32 s100, 200000
    s_waitcnt vmcnt(0)
    s_cbranch_scc1 L_pdone_29
    v_cmp_ne_u64 vcc, s[64:65], v[10:11]
    s_cbranch_vccnz L_poll_28
L_pdone_29:
    s_mov_b64 exec, -1
L_nw3_27:
L_join_24:
    v_lshlrev_b32 v9, 3, v1
    s_barrier
    buffer_load_dwordx2 v[160:161], v9, s[36:39], s21 offen offset:0 sc1
    buffer_load_dwordx2 v[162:163], v9, s[36:39], s21 offen offset:512 sc1
    buffer_load_dwordx2 v[164:165], v9, s[36:39], s21 offen offset:1024 sc1
    buffer_load_dwordx2 v[166:167], v9, s[36:39], s21 offen offset:1536 sc1
    buffer_load_dwordx2 v[168:169], v9, s[36:39], s21 offen offset:2048 sc1
    buffer_load_dwordx2 v[170:171], v9, s[36:39], s21 offen offset:2560 sc1
    buffer_load_dwordx2 v[172:173], v9, s[36:39], s21 offen offset:3072 sc1
    buffer_load_dwordx2 v[174:175], v9, s[36:39], s21 offen offset:3584 sc1
    buffer_load_dwordx4 v[80:83], v46, s[36:39], s20 offen offset:0 sc1
    buffer_load_dwordx4 v[84:87], v46, s[36:39], s20 offen offset:256 sc1
    buffer_load_dwordx4 v[88:91], v46, s[36:39], s20 offen offset:512 sc1
    buffer_load_dwordx4 v[92:95], v46, s[36:39], s20 offen offset:768 sc1
    s_add_u32 s20, s20, 131072
    buffer_load_dwordx4 v[96:99], v46, s[36:39], s20 offen offset:0 sc1
    s_lshl_b32 s70, s91, 11
    v_add_u32 v9, s70, v4
    s_sub_u32 s70, 2048, s70
    v_add_u32 v10, s70, v4
    v_add_u32 v11, 0x10000, v9
    v_add_u32 v12, 0x10000, v10
    v_sub_u32 v13, v21, v20
    v_add_u32 v13, v13, v46
    s_sub_u32 s70, s92, 81920
    v_add_u32 v14, s70, v4
    s_mov_b32 s72, 0x3acccccd
    s_mov_b32 s73, 0x3727c5ac
    buffer_load_dwordx4 v[100:103], v46, s[36:39], s20 offen offset:256 sc1
    buffer_load_dwordx4 v[104:107], v46, s[36:39], s20 offen offset:512 sc1
    buffer_load_dwordx4 v[108:111], v46, s[36:39], s20 offen offset:768 sc1
    s_add_u32 s20, s20, 131072
    buffer_load_dwordx4 v[112:115], v46, s[36:39], s20 offen offset:0 sc1
    buffer_load_dwordx4 v[116:119], v46, s[36:39], s20 offen offset:256 sc1
    s_waitcnt vmcnt(10)
    v_pk_add_f32 v[160:161], v[160:161], v[168:169]
    v_pk_add_f32 v[162:163], v[162:163], v[170:171]
    v_pk_add_f32 v[164:165], v[164:165], v[172:173]
    v_pk_add_f32 v[166:167], v[166:167], v[174:175]
    v_pk_add_f32 v[160:161], v[160:161], v[162:163]
    v_pk_add_f32 v[164:165], v[164:165], v[166:167]
    v_pk_add_f32 v[160:161], v[160:161], v[164:165]
    v_mul_f32 v160, s72, v160
    v_mul_f32 v161, s72, v161
    v_fma_f32 v161, -v160, v160, v161
    v_max_f32 v161, 0, v161
    v_add_f32 v161, s73, v161
    v_rsq_f32 v161, v161
    buffer_load_dwordx4 v[120:123], v46, s[36:39], s20 offen offset:512 sc1
    v_mul_f32 v160, -v160, v161
    v_mov_b32 v168, v161
    v_mov_b32 v170, v161
    v_mov_b32 v169, v160
    v_mov_b32 v171, v160
    v_permlane16_swap_b32 v168, v170
    s_nop 0
    v_permlane16_swap_b32 v169, v171
    v_mov_b32 v172, v168
    v_mov_b32 v174, v170
    v_mov_b32 v173, v169
    v_mov_b32 v175, v171
    buffer_load_dwordx4 v[124:127], v46, s[36:39], s20 offen offset:768 sc1
    v_permlane32_swap_b32 v168, v172
    v_permlane32_swap_b32 v170, v174
    v_permlane32_swap_b32 v169, v173
    v_permlane32_swap_b32 v171, v175
    s_add_u32 s20, s20, 131072
    buffer_load_dwordx4 v[128:131], v46, s[36:39], s20 offen offset:0 sc1
    s_waitcnt vmcnt(12)
    v_lshlrev_b32 v176, 16, v80
    v_and_b32 v177, s63, v80
    v_lshlrev_b32 v178, 16, v81
    v_and_b32 v179, s63, v81
    v_lshlrev_b32 v180, 16, v82
    v_and_b32 v181, s63, v82
    v_lshlrev_b32 v182, 16, v83
    v_and_b32 v183, s63, v83
    v_pk_fma_f32 v[176:177], v[176:177], v[168:169], v[168:169] op_sel:[0,0,1] op_sel_hi:[1,0,1]
    v_pk_fma_f32 v[178:179], v[178:179], v[168:169], v[168:169] op_sel:[0,0,1] op_sel_hi:[1,0,1]
    v_pk_fma_f32 v[180:181], v[180:181], v[168:169], v[168:169] op_sel:[0,0,1] op_sel_hi:[1,0,1]
    v_pk_fma_f32 v[182:183], v[182:183], v[168:169], v[168:169] op_sel:[0,0,1] op_sel_hi:[1,0,1]
    v_cvt_pk_bf16_f32 v80, v176, v177
    v_cvt_pk_bf16_f32 v81, v178, v179
    v_cvt_pk_bf16_f32 v82, v180, v181
    v_cvt_pk_bf16_f32 v83, v182, v183
    ds_write_b128 v14, v[80:83] offset:0
    buffer_load_dwordx4 v[132:135], v46, s[36:39], s20 offen offset:256 sc1
    s_waitcnt vmcnt(12)
    v_lshlrev_b32 v176, 16, v84
    v_and_b32 v177, s63, v84
    v_lshlrev_b32 v178, 16, v85
    v_and_b32 v179, s63, v85
    v_lshlrev_b32 v180, 16, v86
    v_and_b32 v181, s63, v86
    v_lshlrev_b32 v182, 16, v87
    v_and_b32 v183, s63, v87
    v_pk_fma_f32 v[176:177], v[176:177], v[170:171], v[170:171] op_sel:[0,0,1] op_sel_hi:[1,0,1]
    v_pk_fma_f32 v[178:179], v[178:179], v[170:171], v[170:171] op_sel:[0,0,1] op_sel_hi:[1,0,1]
    v_pk_fma_f32 v[180:181], v[180:181], v[170:171], v[170:171] op_sel:[0,0,1] op_sel_hi:[1,0,1]
    v_pk_fma_f32 v[182:183], v[182:183], v[170:171], v[170:171] op_sel:[0,0,1] op_sel_hi:[1,0,1]
    v_cvt_pk_bf16_f32 v84, v176, v177
    v_cvt_pk_bf16_f32 v85, v178, v179
    v_cvt_pk_bf16_f32 v86, v180, v181
    v_cvt_pk_bf16_f32 v87, v182, v183
    ds_write_b128 v14, v[84:87] offset:1024
    buffer_load_dwordx4 v[136:139], v46, s[36:39], s20 offen offset:512 sc1
    s_waitcnt vmcnt(12)
    v_lshlrev_b32 v176, 16, v88
    v_and_b32 v177, s63, v88
    v_lshlrev_b32 v178, 16, v89
    v_and_b32 v179, s63, v89
    v_lshlrev_b32 v180, 16, v90
    v_and_b32 v181, s63, v90
    v_lshlrev_b32 v182, 16, v91
    v_and_b32 v183, s63, v91
    v_pk_fma_f32 v[176:177], v[176:177], v[172:173], v[172:173] op_sel:[0,0,1] op_sel_hi:[1,0,1]
    v_pk_fma_f32 v[178:179], v[178:179], v[172:173], v[172:173] op_sel:[0,0,1] op_sel_hi:[1,0,1]
    v_pk_fma_f32 v[180:181], v[180:181], v[172:173], v[172:173] op_sel:[0,0,1] op_sel_hi:[1,0,1]
    v_pk_fma_f32 v[182:183], v[182:183], v[172:173], v[172:173] op_sel:[0,0,1] op_sel_hi:[1,0,1]
    v_cvt_pk_bf16_f32 v88, v176, v177
    v_cvt_pk_bf16_f32 v89, v178, v179
    v_cvt_pk_bf16_f32 v90, v180, v181
    v_cvt_pk_bf16_f32 v91, v182, v183
    ds_write_b128 v14, v[88:91] offset:2048
    buffer_load_dwordx4 v[140:143], v46, s[36:39], s20 offen offset:768 sc1
    s_waitcnt vmcnt(12)
    v_lshlrev_b32 v176, 16, v92
    v_and_b32 v177, s63, v92
    v_lshlrev_b32 v178, 16, v93
    v_and_b32 v179, s63, v93
    v_lshlrev_b32 v180, 16, v94
    v_and_b32 v181, s63, v94
    v_lshlrev_b32 v182, 16, v95
    v_and_b32 v183, s63, v95
    v_pk_fma_f32 v[176:177], v[176:177], v[174:175], v[174:175] op_sel:[0,0,1] op_sel_hi:[1,0,1]
    v_pk_fma_f32 v[178:179], v[178:179], v[174:175], v[174:175] op_sel:[0,0,1] op_sel_hi:[1,0,1]
    v_pk_fma_f32 v[180:181], v[180:181], v[174:175], v[174:175] op_sel:[0,0,1] op_sel_hi:[1,0,1]
    v_pk_fma_f32 v[182:183], v[182:183], v[174:175], v[174:175] op_sel:[0,0,1] op_sel_hi:[1,0,1]
    v_cvt_pk_bf16_f32 v92, v176, v177
    v_cvt_pk_bf16_f32 v93, v178, v179
    v_cvt_pk_bf16_f32 v94, v180, v181
    v_cvt_pk_bf16_f32 v95, v182, v183
    ds_write_b128 v14, v[92:95] offset:3072
    s_add_u32 s20, s20, 131072
    buffer_load_dwordx4 v[144:147], v46, s[36:39], s20 offen offset:0 sc1
    s_waitcnt vmcnt(12)
    v_lshlrev_b32 v176, 16, v96
    v_and_b32 v177, s63, v96
    v_lshlrev_b32 v178, 16, v97
    v_and_b32 v179, s63, v97
    v_lshlrev_b32 v180, 16, v98
    v_and_b32 v181, s63, v98
    v_lshlrev_b32 v182, 16, v99
    v_and_b32 v183, s63, v99
    v_pk_fma_f32 v[176:177], v[176:177], v[168:169], v[168:169] op_sel:[0,0,1] op_sel_hi:[1,0,1]
    v_pk_fma_f32 v[178:179], v[178:179], v[168:169], v[168:169] op_sel:[0,0,1] op_sel_hi:[1,0,1]
    v_pk_fma_f32 v[180:181], v[180:181], v[168:169], v[168:169] op_sel:[0,0,1] op_sel_hi:[1,0,1]
    v_pk_fma_f32 v[182:183], v[182:183], v[168:169], v[168:169] op_sel:[0,0,1] op_sel_hi:[1,0,1]
    v_cvt_pk_bf16_f32 v96, v176, v177
    v_cvt_pk_bf16_f32 v97, v178, v179
    v_cvt_pk_bf16_f32 v98, v180, v181
    v_cvt_pk_bf16_f32 v99, v182, v183
    ds_write_b128 v14, v[96:99] offset:4096
    buffer_load_dwordx4 v[148:151], v46, s[36:39], s20 offen offset:256 sc1
    s_waitcnt vmcnt(12)
    v_lshlrev_b32 v176, 16, v100
    v_and_b32 v177, s63, v100
    v_lshlrev_b32 v178, 16, v101
    v_and_b32 v179, s63, v101
    v_lshlrev_b32 v180, 16, v102
    v_and_b32 v181, s63, v102
    v_lshlrev_b32 v182, 16, v103
    v_and_b32 v183, s63, v103
    v_pk_fma_f32 v[176:177], v[176:177], v[170:171], v[170:171] op_sel:[0,0,1] op_sel_hi:[1,0,1]
    v_pk_fma_f32 v[178:179], v[178:179], v[170:171], v[170:171] op_sel:[0,0,1] op_sel_hi:[1,0,1]
    v_pk_fma_f32 v[180:181], v[180:181], v[170:171], v[170:171] op_sel:[0,0,1] op_sel_hi:[1,0,1]
    v_pk_fma_f32 v[182:183], v[182:183], v[170:171], v[170:171] op_sel:[0,0,1] op_sel_hi:[1,0,1]
    v_cvt_pk_bf16_f32 v100, v176, v177
    v_cvt_pk_bf16_f32 v101, v178, v179
    v_cvt_pk_bf16_f32 v102, v180, v181
    v_cvt_pk_bf16_f32 v103, v182, v183
    ds_write_b128 v14, v[100:103] offset:5120
    buffer_load_dwordx4 v[152:155], v46, s[36:39], s20 offen offset:512 sc1
    s_waitcnt vmcnt(12)
    v_lshlrev_b32 v176, 16, v104
    v_and_b32 v177, s63, v104
    v_lshlrev_b32 v178, 16, v105
    v_and_b32 v179, s63, v105
    v_lshlrev_b32 v180, 16, v106
    v_and_b32 v181, s63, v106
    v_lshlrev_b32 v182, 16, v107
    v_and_b32 v183, s63, v107
    v_pk_fma_f32 v[176:177], v[176:177], v[172:173], v[172:173] op_sel:[0,0,1] op_sel_hi:[1,0,1]
    v_pk_fma_f32 v[178:179], v[178:179], v[172:173], v[172:173] op_sel:[0,0,1] op_sel_hi:[1,0,1]
    v_pk_fma_f32 v[180:181], v[180:181], v[172:173], v[172:173] op_sel:[0,0,1] op_sel_hi:[1,0,1]
    v_pk_fma_f32 v[182:183], v[182:183], v[172:173], v[172:173] op_sel:[0,0,1] op_sel_hi:[1,0,1]
    v_cvt_pk_bf16_f32 v104, v176, v177
    v_cvt_pk_bf16_f32 v105, v178, v179
    v_cvt_pk_bf16_f32 v106, v180, v181
    v_cvt_pk_bf16_f32 v107, v182, v183
    ds_write_b128 v14, v[104:107] offset:6144
    buffer_load_dwordx4 v[156:159], v46, s[36:39], s20 offen offset:768 sc1
    s_waitcnt vmcnt(12)
    v_lshlrev_b32 v176, 16, v108
    v_and_b32 v177, s63, v108
    v_lshlrev_b32 v178, 16, v109
    v_and_b32 v179, s63, v109
    v_lshlrev_b32 v180, 16, v110
    v_and_b32 v181, s63, v110
    v_lshlrev_b32 v182, 16, v111
    v_and_b32 v183, s63, v111
    v_pk_fma_f32 v[176:177], v[176:177], v[174:175], v[174:175] op_sel:[0,0,1] op_sel_hi:[1,0,1]
    v_pk_fma_f32 v[178:179], v[178:179], v[174:175], v[174:175] op_sel:[0,0,1] op_sel_hi:[1,0,1]
    v_pk_fma_f32 v[180:181], v[180:181], v[174:175], v[174:175] op_sel:[0,0,1] op_sel_hi:[1,0,1]
    v_pk_fma_f32 v[182:183], v[182:183], v[174:175], v[174:175] op_sel:[0,0,1] op_sel_hi:[1,0,1]
    v_cvt_pk_bf16_f32 v108, v176, v177
    v_cvt_pk_bf16_f32 v109, v178, v179
    v_cvt_pk_bf16_f32 v110, v180, v181
    v_cvt_pk_bf16_f32 v111, v182, v183
    ds_write_b128 v14, v[108:111] offset:7168
    s_waitcnt vmcnt(11)
    v_lshlrev_b32 v176, 16, v112
    v_and_b32 v177, s63, v112
    v_lshlrev_b32 v178, 16, v113
    v_and_b32 v179, s63, v113
    v_lshlrev_b32 v180, 16, v114
    v_and_b32 v181, s63, v114
    v_lshlrev_b32 v182, 16, v115
    v_and_b32 v183, s63, v115
    v_pk_fma_f32 v[176:177], v[176:177], v[168:169], v[168:169] op_sel:[0,0,1] op_sel_hi:[1,0,1]
    v_pk_fma_f32 v[178:179], v[178:179], v[168:169], v[168:169] op_sel:[0,0,1] op_sel_hi:[1,0,1]
    v_pk_fma_f32 v[180:181], v[180:181], v[168:169], v[168:169] op_sel:[0,0,1] op_sel_hi:[1,0,1]
    v_pk_fma_f32 v[182:183], v[182:183], v[168:169], v[168:169] op_sel:[0,0,1] op_sel_hi:[1,0,1]
    v_cvt_pk_bf16_f32 v112, v176, v177
    v_cvt_pk_bf16_f32 v113, v178, v179
    v_cvt_pk_bf16_f32 v114, v180, v181
    v_cvt_pk_bf16_f32 v115, v182, v183
    ds_write_b128 v14, v[112:115] offset:8192
    s_waitcnt vmcnt(10)
    v_lshlrev_b32 v176, 16, v116
    v_and_b32 v177, s63, v116
    v_lshlrev_b32 v178, 16, v117
    buffer_load_dwordx4 a[244:247], v4, s[36:39], s48 offen offset:2048 sc1
    v_and_b32 v179, s63, v117
    v_lshlrev_b32 v180, 16, v118
    v_and_b32 v181, s63, v118
    v_lshlrev_b32 v182, 16, v119
    v_and_b32 v183, s63, v119
    v_pk_fma_f32 v[176:177], v[176:177], v[170:171], v[170:171] op_sel:[0,0,1] op_sel_hi:[1,0,1]
    v_pk_fma_f32 v[178:179], v[178:179], v[170:171], v[170:171] op_sel:[0,0,1] op_sel_hi:[1,0,1]
    v_pk_fma_f32 v[180:181], v[180:181], v[170:171], v[170:171] op_sel:[0,0,1] op_sel_hi:[1,0,1]
    v_pk_fma_f32 v[182:183], v[182:183], v[170:171], v[170:171] op_sel:[0,0,1] op_sel_hi:[1,0,1]
    v_cvt_pk_bf16_f32 v116, v176, v177
    v_cvt_pk_bf16_f32 v117, v178, v179
    v_cvt_pk_bf16_f32 v118, v180, v181
    v_cvt_pk_bf16_f32 v119, v182, v183
    ds_write_b128 v14, v[116:119] offset:9216
    s_waitcnt vmcnt(10)
    v_lshlrev_b32 v176, 16, v120
    v_and_b32 v177, s63, v120
    v_lshlrev_b32 v178, 16, v121
    v_and_b32 v179, s63, v121
    v_lshlrev_b32 v180, 16, v122
    v_and_b32 v181, s63, v122
    buffer_load_dwordx4 a[248:251], v4, s[36:39], s49 offen offset:2048 sc1
    v_lshlrev_b32 v182, 16, v123
    v_and_b32 v183, s63, v123
    v_pk_fma_f32 v[176:177], v[176:177], v[172:173], v[172:173] op_sel:[0,0,1] op_sel_hi:[1,0,1]
    v_pk_fma_f32 v[178:179], v[178:179], v[172:173], v[172:173] op_sel:[0,0,1] op_sel_hi:[1,0,1]
    v_pk_fma_f32 v[180:181], v[180:181], v[172:173], v[172:173] op_sel:[0,0,1] op_sel_hi:[1,0,1]
    v_pk_fma_f32 v[182:183], v[182:183], v[172:173], v[172:173] op_sel:[0,0,1] op_sel_hi:[1,0,1]
    v_cvt_pk_bf16_f32 v120, v176, v177
    v_cvt_pk_bf16_f32 v121, v178, v179
    v_cvt_pk_bf16_f32 v122, v180, v181
    v_cvt_pk_bf16_f32 v123, v182, v183
    ds_write_b128 v14, v[120:123] offset:10240
    s_waitcnt vmcnt(10)
    v_lshlrev_b32 v176, 16, v124
    v_and_b32 v177, s63, v124
    v_lshlrev_b32 v178, 16, v125
    v_and_b32 v179, s63, v125
    v_lshlrev_b32 v180, 16, v126
    v_and_b32 v181, s63, v126
    v_lshlrev_b32 v182, 16, v127
    v_and_b32 v183, s63, v127
    v_pk_fma_f32 v[176:177], v[176:177], v[174:175], v[174:175] op_sel:[0,0,1] op_sel_hi:[1,0,1]
    buffer_load_dwordx4 a[252:255], v4, s[36:39], s48 offen offset:3072 sc1
    v_pk_fma_f32 v[178:179], v[178:179], v[174:175], v[174:175] op_sel:[0,0,1] op_sel_hi:[1,0,1]
    v_pk_fma_f32 v[180:181], v[180:181], v[174:175], v[174:175] op_sel:[0,0,1] op_sel_hi:[1,0,1]
    v_pk_fma_f32 v[182:183], v[182:183], v[174:175], v[174:175] op_sel:[0,0,1] op_sel_hi:[1,0,1]
    v_cvt_pk_bf16_f32 v124, v176, v177
    v_cvt_pk_bf16_f32 v125, v178, v179
    v_cvt_pk_bf16_f32 v126, v180, v181
    v_cvt_pk_bf16_f32 v127, v182, v183
    ds_write_b128 v14, v[124:127] offset:11264
    s_waitcnt vmcnt(10)
    v_lshlrev_b32 v176, 16, v128
    v_and_b32 v177, s63, v128
    v_lshlrev_b32 v178, 16, v129
    v_and_b32 v179, s63, v129
    v_lshlrev_b32 v180, 16, v130
    v_and_b32 v181, s63, v130
    v_lshlrev_b32 v182, 16, v131
    v_and_b32 v183, s63, v131
    v_pk_fma_f32 v[176:177], v[176:177], v[168:169], v[168:169] op_sel:[0,0,1] op_sel_hi:[1,0,1]
    v_pk_fma_f32 v[178:179], v[178:179], v[168:169], v[168:169] op_sel:[0,0,1] op_sel_hi:[1,0,1]
    v_pk_fma_f32 v[180:181], v[180:181], v[168:169], v[168:169] op_sel:[0,0,1] op_sel_hi:[1,0,1]
    v_pk_fma_f32 v[182:183], v[182:183], v[168:169], v[168:169] op_sel:[0,0,1] op_sel_hi:[1,0,1]
    buffer_load_dwordx4 a[0:3], v4, s[36:39], s49 offen offset:3072 sc1
    v_cvt_pk_bf16_f32 v128, v176, v177
    v_cvt_pk_bf16_f32 v129, v178, v179
    v_cvt_pk_bf16_f32 v130, v180, v181
    v_cvt_pk_bf16_f32 v131, v182, v183
    ds_write_b128 v14, v[128:131] offset:12288
    s_waitcnt vmcnt(10)
    v_lshlrev_b32 v176, 16, v132
    v_and_b32 v177, s63, v132
    v_lshlrev_b32 v178, 16, v133
    v_and_b32 v179, s63, v133
    v_lshlrev_b32 v180, 16, v134
    v_and_b32 v181, s63, v134
    v_lshlrev_b32 v182, 16, v135
    v_and_b32 v183, s63, v135
    v_pk_fma_f32 v[176:177], v[176:177], v[170:171], v[170:171] op_sel:[0,0,1] op_sel_hi:[1,0,1]
    v_pk_fma_f32 v[178:179], v[178:179], v[170:171], v[170:171] op_sel:[0,0,1] op_sel_hi:[1,0,1]
    v_pk_fma_f32 v[180:181], v[180:181], v[170:171], v[170:171] op_sel:[0,0,1] op_sel_hi:[1,0,1]
    v_pk_fma_f32 v[182:183], v[182:183], v[170:171], v[170:171] op_sel:[0,0,1] op_sel_hi:[1,0,1]
    v_cvt_pk_bf16_f32 v132, v176, v177
    v_cvt_pk_bf16_f32 v133, v178, v179
    v_cvt_pk_bf16_f32 v134, v180, v181
    s_add_u32 s48, s87, 40960
    buffer_load_dwordx4 a[4:7], v4, s[36:39], s48 offen offset:0 sc1
    v_cvt_pk_bf16_f32 v135, v182, v183
    ds_write_b128 v14, v[132:135] offset:13312
    s_waitcnt vmcnt(10)
    v_lshlrev_b32 v176, 16, v136
    v_and_b32 v177, s63, v136
    v_lshlrev_b32 v178, 16, v137
    v_and_b32 v179, s63, v137
    v_lshlrev_b32 v180, 16, v138
    v_and_b32 v181, s63, v138
    v_lshlrev_b32 v182, 16, v139
    v_and_b32 v183, s63, v139
    v_pk_fma_f32 v[176:177], v[176:177], v[172:173], v[172:173] op_sel:[0,0,1] op_sel_hi:[1,0,1]
    v_pk_fma_f32 v[178:179], v[178:179], v[172:173], v[172:173] op_sel:[0,0,1] op_sel_hi:[1,0,1]
    v_pk_fma_f32 v[180:181], v[180:181], v[172:173], v[172:173] op_sel:[0,0,1] op_sel_hi:[1,0,1]
    v_pk_fma_f32 v[182:183], v[182:183], v[172:173], v[172:173] op_sel:[0,0,1] op_sel_hi:[1,0,1]
    v_cvt_pk_bf16_f32 v136, v176, v177
    v_cvt_pk_bf16_f32 v137, v178, v179
    v_cvt_pk_bf16_f32 v138, v180, v181
    v_cvt_pk_bf16_f32 v139, v182, v183
    ds_write_b128 v14, v[136:139] offset:14336
    s_waitcnt vmcnt(9)
    v_lshlrev_b32 v176, 16, v140
    s_add_u32 s49, s88, 0
    buffer_load_dwordx4 a[8:11], v4, s[36:39], s49 offen offset:0 sc1
    v_and_b32 v177, s63, v140
    v_lshlrev_b32 v178, 16, v141
    v_and_b32 v179, s63, v141
    v_lshlrev_b32 v180, 16, v142
    v_and_b32 v181, s63, v142
    v_lshlrev_b32 v182, 16, v143
    v_and_b32 v183, s63, v143
    v_pk_fma_f32 v[176:177], v[176:177], v[174:175], v[174:175] op_sel:[0,0,1] op_sel_hi:[1,0,1]
    v_pk_fma_f32 v[178:179], v[178:179], v[174:175], v[174:175] op_sel:[0,0,1] op_sel_hi:[1,0,1]
    v_pk_fma_f32 v[180:181], v[180:181], v[174:175], v[174:175] op_sel:[0,0,1] op_sel_hi:[1,0,1]
    v_pk_fma_f32 v[182:183], v[182:183], v[174:175], v[174:175] op_sel:[0,0,1] op_sel_hi:[1,0,1]
    v_cvt_pk_bf16_f32 v140, v176, v177
    v_cvt_pk_bf16_f32 v141, v178, v179
    v_cvt_pk_bf16_f32 v142, v180, v181
    v_cvt_pk_bf16_f32 v143, v182, v183
    ds_write_b128 v14, v[140:143] offset:15360
    s_waitcnt vmcnt(9)
    v_lshlrev_b32 v176, 16, v144
    v_and_b32 v177, s63, v144
    v_lshlrev_b32 v178, 16, v145
    v_and_b32 v179, s63, v145
    buffer_load_dwordx4 a[12:15], v4, s[36:39], s48 offen offset:1024 sc1
    v_lshlrev_b32 v180, 16, v146
    v_and_b32 v181, s63, v146
    v_lshlrev_b32 v182, 16, v147
    v_and_b32 v183, s63, v147
    v_pk_fma_f32 v[176:177], v[176:177], v[168:169], v[168:169] op_sel:[0,0,1] op_sel_hi:[1,0,1]
    v_pk_fma_f32 v[178:179], v[178:179], v[168:169], v[168:169] op_sel:[0,0,1] op_sel_hi:[1,0,1]
    v_pk_fma_f32 v[180:181], v[180:181], v[168:169], v[168:169] op_sel:[0,0,1] op_sel_hi:[1,0,1]
    v_pk_fma_f32 v[182:183], v[182:183], v[168:169], v[168:169] op_sel:[0,0,1] op_sel_hi:[1,0,1]
    v_cvt_pk_bf16_f32 v144, v176, v177
    v_cvt_pk_bf16_f32 v145, v178, v179
    v_cvt_pk_bf16_f32 v146, v180, v181
    v_cvt_pk_bf16_f32 v147, v182, v183
    ds_write_b128 v14, v[144:147] offset:16384
    s_waitcnt vmcnt(9)
    v_lshlrev_b32 v176, 16, v148
    v_and_b32 v177, s63, v148
    v_lshlrev_b32 v178, 16, v149
    v_and_b32 v179, s63, v149
    v_lshlrev_b32 v180, 16, v150
    v_and_b32 v181, s63, v150
    v_lshlrev_b32 v182, 16, v151
    buffer_load_dwordx4 a[16:19], v4, s[36:39], s49 offen offset:1024 sc1
    v_and_b32 v183, s63, v151
    v_pk_fma_f32 v[176:177], v[176:177], v[170:171], v[170:171] op_sel:[0,0,1] op_sel_hi:[1,0,1]
    v_pk_fma_f32 v[178:179], v[178:179], v[170:171], v[170:171] op_sel:[0,0,1] op_sel_hi:[1,0,1]
    v_pk_fma_f32 v[180:181], v[180:181], v[170:171], v[170:171] op_sel:[0,0,1] op_sel_hi:[1,0,1]
    v_pk_fma_f32 v[182:183], v[182:183], v[170:171], v[170:171] op_sel:[0,0,1] op_sel_hi:[1,0,1]
    v_cvt_pk_bf16_f32 v148, v176, v177
    v_cvt_pk_bf16_f32 v149, v178, v179
    v_cvt_pk_bf16_f32 v150, v180, v181
    v_cvt_pk_bf16_f32 v151, v182, v183
    ds_write_b128 v14, v[148:151] offset:17408
    s_waitcnt vmcnt(9)
    v_lshlrev_b32 v176, 16, v152
    v_and_b32 v177, s63, v152
    v_lshlrev_b32 v178, 16, v153
    v_and_b32 v179, s63, v153
    v_lshlrev_b32 v180, 16, v154
    v_and_b32 v181, s63, v154
    v_lshlrev_b32 v182, 16, v155
    v_and_b32 v183, s63, v155
    v_pk_fma_f32 v[176:177], v[176:177], v[172:173], v[172:173] op_sel:[0,0,1] op_sel_hi:[1,0,1]
    v_pk_fma_f32 v[178:179], v[178:179], v[172:173], v[172:173] op_sel:[0,0,1] op_sel_hi:[1,0,1]
    buffer_load_dwordx4 a[20:23], v4, s[36:39], s48 offen offset:2048 sc1
    v_pk_fma_f32 v[180:181], v[180:181], v[172:173], v[172:173] op_sel:[0,0,1] op_sel_hi:[1,0,1]
    v_pk_fma_f32 v[182:183], v[182:183], v[172:173], v[172:173] op_sel:[0,0,1] op_sel_hi:[1,0,1]
    v_cvt_pk_bf16_f32 v152, v176, v177
    v_cvt_pk_bf16_f32 v153, v178, v179
    v_cvt_pk_bf16_f32 v154, v180, v181
    v_cvt_pk_bf16_f32 v155, v182, v183
    ds_write_b128 v14, v[152:155] offset:18432
    s_waitcnt vmcnt(9)
    v_lshlrev_b32 v176, 16, v156
    v_and_b32 v177, s63, v156
    v_lshlrev_b32 v178, 16, v157
    v_and_b32 v179, s63, v157
    v_lshlrev_b32 v180, 16, v158
    v_and_b32 v181, s63, v158
    v_lshlrev_b32 v182, 16, v159
    v_and_b32 v183, s63, v159
    v_pk_fma_f32 v[176:177], v[176:177], v[174:175], v[174:175] op_sel:[0,0,1] op_sel_hi:[1,0,1]
    v_pk_fma_f32 v[178:179], v[178:179], v[174:175], v[174:175] op_sel:[0,0,1] op_sel_hi:[1,0,1]
    v_pk_fma_f32 v[180:181], v[180:181], v[174:175], v[174:175] op_sel:[0,0,1] op_sel_hi:[1,0,1]
    v_pk_fma_f32 v[182:183], v[182:183], v[174:175], v[174:175] op_sel:[0,0,1] op_sel_hi:[1,0,1]
    v_cvt_pk_bf16_f32 v156, v176, v177
    buffer_load_dwordx4 a[24:27], v4, s[36:39], s49 offen offset:2048 sc1
    v_cvt_pk_bf16_f32 v157, v178, v179
    v_cvt_pk_bf16_f32 v158, v180, v181
    v_cvt_pk_bf16_f32 v159, v182, v183
    ds_write_b128 v14, v[156:159] offset:19456
    s_waitcnt lgkmcnt(0)
    s_barrier
    ds_read_b128 v[160:163], v9 offset:0
    ds_read_b128 v[164:167], v9 offset:1024
    ds_read_b128 v[168:171], v10 offset:0
    ds_read_b128 v[172:175], v10 offset:1024
    s_waitcnt lgkmcnt(2)
    v_mfma_f32_16x16x32_bf16 v[80:83], a[100:103], v[160:163], 0
    ds_read_b128 v[176:179], v9 offset:4096
    v_mfma_f32_16x16x32_bf16 v[84:87], a[104:107], v[160:163], 0
    v_mfma_f32_16x16x32_bf16 v[88:91], a[100:103], v[164:167], 0
    ds_read_b128 v[180:183], v9 offset:5120
    v_mfma_f32_16x16x32_bf16 v[92:95], a[104:107], v[164:167], 0
    buffer_load_dwordx4 a[28:31], v4, s[36:39], s48 offen offset:3072 sc1
    s_waitcnt lgkmcnt(2)
    v_mfma_f32_16x16x32_bf16 v[96:99], a[100:103], v[168:171], 0
    ds_read_b128 v[184:187], v10 offset:4096
    v_mfma_f32_16x16x32_bf16 v[100:103], a[104:107], v[168:171], 0
    v_mfma_f32_16x16x32_bf16 v[104:107], a[100:103], v[172:175], 0
    ds_read_b128 v[188:191], v10 offset:5120
    v_mfma_f32_16x16x32_bf16 v[108:111], a[104:107], v[172:175], 0
    s_waitcnt lgkmcnt(2)
    v_mfma_f32_16x16x32_bf16 v[80:83], a[108:111], v[176:179], v[80:83]
    buffer_load_dwordx4 a[32:35], v4, s[36:39], s49 offen offset:3072 sc1
    ds_read_b128 v[160:163], v9 offset:8192
    v_mfma_f32_16x16x32_bf16 v[84:87], a[112:115], v[176:179], v[84:87]
    v_mfma_f32_16x16x32_bf16 v[88:91], a[108:111], v[180:183], v[88:91]
    ds_read_b128 v[164:167], v9 offset:9216
    v_mfma_f32_16x16x32_bf16 v[92:95], a[112:115], v[180:183], v[92:95]
    s_waitcnt lgkmcnt(2)
    v_mfma_f32_16x16x32_bf16 v[96:99], a[108:111], v[184:187], v[96:99]
    ds_read_b128 v[168:171], v10 offset:8192
    v_mfma_f32_16x16x32_bf16 v[100:103], a[112:115], v[184:187], v[100:103]
    s_add_u32 s48, s87, 45056
    buffer_load_dwordx4 a[36:39], v4, s[36:39], s48 offen offset:0 sc1
    v_mfma_f32_16x16x32_bf16 v[104:107], a[108:111], v[188:191], v[104:107]
    ds_read_b128 v[172:175], v10 offset:9216
    v_mfma_f32_16x16x32_bf16 v[108:111], a[112:115], v[188:191], v[108:111]
    s_waitcnt lgkmcnt(2)
    v_mfma_f32_16x16x32_bf16 v[80:83], a[116:119], v[160:163], v[80:83]
    ds_read_b128 v[176:179], v9 offset:12288
    v_mfma_f32_16x16x32_bf16 v[84:87], a[120:123], v[160:163], v[84:87]
    v_mfma_f32_16x16x32_bf16 v[88:91], a[116:119], v[164:167], v[88:91]
    s_add_u32 s49, s88, 4096
    buffer_load_dwordx4 a[40:43], v4, s[36:39], s49 offen offset:0 sc1
    ds_read_b128 v[180:183], v9 offset:13312
    v_mfma_f32_16x16x32_bf16 v[92:95], a[120:123], v[164:167], v[92:95]
    s_waitcnt lgkmcnt(2)
    v_mfma_f32_16x16x32_bf16 v[96:99], a[116:119], v[168:171], v[96:99]
    ds_read_b128 v[184:187], v10 offset:12288
    v_mfma_f32_16x16x32_bf16 v[100:103], a[120:123], v[168:171], v[100:103]
    v_mfma_f32_16x16x32_bf16 v[104:107], a[116:119], v[172:175], v[104:107]
    ds_read_b128 v[188:191], v10 offset:13312
    v_mfma_f32_16x16x32_bf16 v[108:111], a[120:123], v[172:175], v[108:111]
    buffer_load_dwordx4 a[44:47], v4, s[36:39], s48 offen offset:1024 sc1
    s_waitcnt lgkmcnt(2)
    v_mfma_f32_16x16x32_bf16 v[80:83], a[124:127], v[176:179], v[80:83]
    ds_read_b128 v[160:163], v9 offset:16384
    v_mfma_f32_16x16x32_bf16 v[84:87], a[128:131], v[176:179], v[84:87]
    v_mfma_f32_16x16x32_bf16 v[88:91], a[124:127], v[180:183], v[88:91]
    ds_read_b128 v[164:167], v9 offset:17408
    v_mfma_f32_16x16x32_bf16 v[92:95], a[128:131], v[180:183], v[92:95]
    s_waitcnt lgkmcnt(2)
    v_mfma_f32_16x16x32_bf16 v[96:99], a[124:127], v[184:187], v[96:99]
    buffer_load_dwordx4 a[48:51], v4, s[36:39], s49 offen offset:1024 sc1
    ds_read_b128 v[168:171], v10 offset:16384
    v_mfma_f32_16x16x32_bf16 v[100:103], a[128:131], v[184:187], v[100:103]
    v_mfma_f32_16x16x32_bf16 v[104:107], a[124:127], v[188:191], v[104:107]
    ds_read_b128 v[172:175], v10 offset:17408
    v_mfma_f32_16x16x32_bf16 v[108:111], a[128:131], v[188:191], v[108:111]
    s_waitcnt lgkmcnt(2)
    v_mfma_f32_16x16x32_bf16 v[80:83], a[132:135], v[160:163], v[80:83]
    ds_read_b128 v[176:179], v9 offset:20480
    v_mfma_f32_16x16x32_bf16 v[84:87], a[136:139], v[160:163], v[84:87]
    buffer_load_dwordx4 a[52:55], v4, s[36:39], s48 offen offset:2048 sc1
    v_mfma_f32_16x16x32_bf16 v[88:91], a[132:135], v[164:167], v[88:91]
    ds_read_b128 v[180:183], v9 offset:21504
    v_mfma_f32_16x16x32_bf16 v[92:95], a[136:139], v[164:167], v[92:95]
    s_waitcnt lgkmcnt(2)
    v_mfma_f32_16x16x32_bf16 v[96:99], a[132:135], v[168:171], v[96:99]
    ds_read_b128 v[184:187], v10 offset:20480
    v_mfma_f32_16x16x32_bf16 v[100:103], a[136:139], v[168:171], v[100:103]
    v_mfma_f32_16x16x32_bf16 v[104:107], a[132:135], v[172:175], v[104:107]
    buffer_load_dwordx4 a[56:59], v4, s[36:39], s49 offen offset:2048 sc1
    ds_read_b128 v[188:191], v10 offset:21504
    v_mfma_f32_16x16x32_bf16 v[108:111], a[136:139], v[172:175], v[108:111]
    s_waitcnt lgkmcnt(2)
    v_mfma_f32_16x16x32_bf16 v[80:83], a[140:143], v[176:179], v[80:83]
    ds_read_b128 v[160:163], v9 offset:24576
    v_mfma_f32_16x16x32_bf16 v[84:87], a[144:147], v[176:179], v[84:87]
    v_mfma_f32_16x16x32_bf16 v[88:91], a[140:143], v[180:183], v[88:91]
    ds_read_b128 v[164:167], v9 offset:25600
    v_mfma_f32_16x16x32_bf16 v[92:95], a[144:147], v[180:183], v[92:95]
    buffer_load_dwordx4 a[60:63], v4, s[36:39], s48 offen offset:3072 sc1
    s_waitcnt lgkmcnt(2)
    v_mfma_f32_16x16x32_bf16 v[96:99], a[140:143], v[184:187], v[96:99]
    ds_read_b128 v[168:171], v10 offset:24576
    v_mfma_f32_16x16x32_bf16 v[100:103], a[144:147], v[184:187], v[100:103]
    v_mfma_f32_16x16x32_bf16 v[104:107], a[140:143], v[188:191], v[104:107]
    ds_read_b128 v[172:175], v10 offset:25600
    v_mfma_f32_16x16x32_bf16 v[108:111], a[144:147], v[188:191], v[108:111]
    s_waitcnt lgkmcnt(2)
    v_mfma_f32_16x16x32_bf16 v[80:83], a[148:151], v[160:163], v[80:83]
    buffer_load_dwordx4 a[64:67], v4, s[36:39], s49 offen offset:3072 sc1
    ds_read_b128 v[176:179], v9 offset:28672
    v_mfma_f32_16x16x32_bf16 v[84:87], a[152:155], v[160:163], v[84:87]
    v_mfma_f32_16x16x32_bf16 v[88:91], a[148:151], v[164:167], v[88:91]
    ds_read_b128 v[180:183], v9 offset:29696
    v_mfma_f32_16x16x32_bf16 v[92:95], a[152:155], v[164:167], v[92:95]
    s_waitcnt lgkmcnt(2)
    v_mfma_f32_16x16x32_bf16 v[96:99], a[148:151], v[168:171], v[96:99]
    ds_read_b128 v[184:187], v10 offset:28672
    v_mfma_f32_16x16x32_bf16 v[100:103], a[152:155], v[168:171], v[100:103]
    s_add_u32 s48, s87, 49152
    buffer_load_dwordx4 a[68:71], v4, s[36:39], s48 offen offset:0 sc1
    v_mfma_f32_16x16x32_bf16 v[104:107], a[148:151], v[172:175], v[104:107]
    ds_read_b128 v[188:191], v10 offset:29696
    v_mfma_f32_16x16x32_bf16 v[108:111], a[152:155], v[172:175], v[108:111]
    s_waitcnt lgkmcnt(2)
    v_mfma_f32_16x16x32_bf16 v[80:83], a[156:159], v[176:179], v[80:83]
    ds_read_b128 v[160:163], v9 offset:32768
    v_mfma_f32_16x16x32_bf16 v[84:87], a[160:163], v[176:179], v[84:87]
    v_mfma_f32_16x16x32_bf16 v[88:91], a[156:159], v[180:183], v[88:91]
    s_add_u32 s49, s88, 8192
    buffer_load_dwordx4 a[72:75], v4, s[36:39], s49 offen offset:0 sc1
    ds_read_b128 v[164:167], v9 offset:33792
    v_mfma_f32_16x16x32_bf16 v[92:95], a[160:163], v[180:183], v[92:95]
    s_waitcnt lgkmcnt(2)
    v_mfma_f32_16x16x32_bf16 v[96:99], a[156:159], v[184:187], v[96:99]
    ds_read_b128 v[168:171], v10 offset:32768
    v_mfma_f32_16x16x32_bf16 v[100:103], a[160:163], v[184:187], v[100:103]
    v_mfma_f32_16x16x32_bf16 v[104:107], a[156:159], v[188:191], v[104:107]
    ds_read_b128 v[172:175], v10 offset:33792
    v_mfma_f32_16x16x32_bf16 v[108:111], a[160:163], v[188:191], v[108:111]
    buffer_load_dwordx4 a[76:79], v4, s[36:39], s48 offen offset:1024 sc1
    s_waitcnt lgkmcnt(2)
    v_mfma_f32_16x16x32_bf16 v[80:83], a[164:167], v[160:163], v[80:83]
    ds_read_b128 v[176:179], v9 offset:36864
    v_mfma_f32_16x16x32_bf16 v[84:87], a[168:171], v[160:163], v[84:87]
    v_mfma_f32_16x16x32_bf16 v[88:91], a[164:167], v[164:167], v[88:91]
    ds_read_b128 v[180:183], v9 offset:37888
    v_mfma_f32_16x16x32_bf16 v[92:95], a[168:171], v[164:167], v[92:95]
    s_waitcnt lgkmcnt(2)
    v_mfma_f32_16x16x32_bf16 v[96:99], a[164:167], v[168:171], v[96:99]
    buffer_load_dwordx4 a[80:83], v4, s[36:39], s49 offen offset:1024 sc1
    ds_read_b128 v[184:187], v10 offset:36864
    v_mfma_f32_16x16x32_bf16 v[100:103], a[168:171], v[168:171], v[100:103]
    v_mfma_f32_16x16x32_bf16 v[104:107], a[164:167], v[172:175], v[104:107]
    ds_read_b128 v[188:191], v10 offset:37888
    v_mfma_f32_16x16x32_bf16 v[108:111], a[168:171], v[172:175], v[108:111]
    s_waitcnt lgkmcnt(2)
    v_mfma_f32_16x16x32_bf16 v[80:83], a[172:175], v[176:179], v[80:83]
    ds_read_b128 v[160:163], v9 offset:40960
    v_mfma_f32_16x16x32_bf16 v[84:87], a[176:179], v[176:179], v[84:87]
    buffer_load_dwordx4 a[84:87], v4, s[36:39], s48 offen offset:2048 sc1
    v_mfma_f32_16x16x32_bf16 v[88:91], a[172:175], v[180:183], v[88:91]
    ds_read_b128 v[164:167], v9 offset:41984
    v_mfma_f32_16x16x32_bf16 v[92:95], a[176:179], v[180:183], v[92:95]
    s_waitcnt lgkmcnt(2)
    v_mfma_f32_16x16x32_bf16 v[96:99], a[172:175], v[184:187], v[96:99]
    ds_read_b128 v[168:171], v10 offset:40960
    v_mfma_f32_16x16x32_bf16 v[100:103], a[176:179], v[184:187], v[100:103]
    v_mfma_f32_16x16x32_bf16 v[104:107], a[172:175], v[188:191], v[104:107]
    buffer_load_dwordx4 a[88:91], v4, s[36:39], s49 offen offset:2048 sc1
    ds_read_b128 v[172:175], v10 offset:41984
    v_mfma_f32_16x16x32_bf16 v[108:111], a[176:179], v[188:191], v[108:111]
    s_waitcnt lgkmcnt(2)
    v_mfma_f32_16x16x32_bf16 v[80:83], a[180:183], v[160:163], v[80:83]
    ds_read_b128 v[176:179], v9 offset:45056
    v_mfma_f32_16x16x32_bf16 v[84:87], a[184:187], v[160:163], v[84:87]
    v_mfma_f32_16x16x32_bf16 v[88:91], a[180:183], v[164:167], v[88:91]
    ds_read_b128 v[180:183], v9 offset:46080
    v_mfma_f32_16x16x32_bf16 v[92:95], a[184:187], v[164:167], v[92:95]
    buffer_load_dwordx4 a[92:95], v4, s[36:39], s48 offen offset:3072 sc1
    s_waitcnt lgkmcnt(2)
    v_mfma_f32_16x16x32_bf16 v[96:99], a[180:183], v[168:171], v[96:99]
    ds_read_b128 v[184:187], v10 offset:45056
    v_mfma_f32_16x16x32_bf16 v[100:103], a[184:187], v[168:171], v[100:103]
    v_mfma_f32_16x16x32_bf16 v[104:107], a[180:183], v[172:175], v[104:107]
    ds_read_b128 v[188:191], v10 offset:46080
    v_mfma_f32_16x16x32_bf16 v[108:111], a[184:187], v[172:175], v[108:111]
    s_waitcnt lgkmcnt(2)
    v_mfma_f32_16x16x32_bf16 v[80:83], a[188:191], v[176:179], v[80:83]
    buffer_load_dwordx4 a[96:99], v4, s[36:39], s49 offen offset:3072 sc1
    ds_read_b128 v[160:163], v9 offset:49152
    v_mfma_f32_16x16x32_bf16 v[84:87], a[192:195], v[176:179], v[84:87]
    v_mfma_f32_16x16x32_bf16 v[88:91], a[188:191], v[180:183], v[88:91]
    ds_read_b128 v[164:167], v9 offset:50176
    v_mfma_f32_16x16x32_bf16 v[92:95], a[192:195], v[180:183], v[92:95]
    s_waitcnt lgkmcnt(2)
    v_mfma_f32_16x16x32_bf16 v[96:99], a[188:191], v[184:187], v[96:99]
    ds_read_b128 v[168:171], v10 offset:49152
    v_mfma_f32_16x16x32_bf16 v[100:103], a[192:195], v[184:187], v[100:103]
    s_add_u32 s48, s87, 53248
    buffer_load_dwordx4 v[224:227], v4, s[36:39], s48 offen offset:0 sc1
    v_mfma_f32_16x16x32_bf16 v[104:107], a[188:191], v[188:191], v[104:107]
    ds_read_b128 v[172:175], v10 offset:50176
    v_mfma_f32_16x16x32_bf16 v[108:111], a[192:195], v[188:191], v[108:111]
    s_waitcnt lgkmcnt(2)
    v_mfma_f32_16x16x32_bf16 v[80:83], a[196:199], v[160:163], v[80:83]
    ds_read_b128 v[176:179], v9 offset:53248
    v_mfma_f32_16x16x32_bf16 v[84:87], a[200:203], v[160:163], v[84:87]
    v_mfma_f32_16x16x32_bf16 v[88:91], a[196:199], v[164:167], v[88:91]
    s_add_u32 s49, s88, 12288
    buffer_load_dwordx4 v[228:231], v4, s[36:39], s49 offen offset:0 sc1
    ds_read_b128 v[180:183], v9 offset:54272
    v_mfma_f32_16x16x32_bf16 v[92:95], a[200:203], v[164:167], v[92:95]
    s_waitcnt lgkmcnt(2)
    v_mfma_f32_16x16x32_bf16 v[96:99], a[196:199], v[168:171], v[96:99]
    ds_read_b128 v[184:187], v10 offset:53248
    v_mfma_f32_16x16x32_bf16 v[100:103], a[200:203], v[168:171], v[100:103]
    v_mfma_f32_16x16x32_bf16 v[104:107], a[196:199], v[172:175], v[104:107]
    ds_read_b128 v[188:191], v10 offset:54272
    v_mfma_f32_16x16x32_bf16 v[108:111], a[200:203], v[172:175], v[108:111]
    buffer_load_dwordx4 v[232:235], v4, s[36:39], s48 offen offset:1024 sc1
    s_waitcnt lgkmcnt(2)
    v_mfma_f32_16x16x32_bf16 v[80:83], a[204:207], v[176:179], v[80:83]
    ds_read_b128 v[160:163], v9 offset:57344
    v_mfma_f32_16x16x32_bf16 v[84:87], a[208:211], v[176:179], v[84:87]
    v_mfma_f32_16x16x32_bf16 v[88:91], a[204:207], v[180:183], v[88:91]
    ds_read_b128 v[164:167], v9 offset:58368
    v_mfma_f32_16x16x32_bf16 v[92:95], a[208:211], v[180:183], v[92:95]
    s_waitcnt lgkmcnt(2)
    v_mfma_f32_16x16x32_bf16 v[96:99], a[204:207], v[184:187], v[96:99]
    buffer_load_dwordx4 v[236:239], v4, s[36:39], s49 offen offset:1024 sc1
    ds_read_b128 v[168:171], v10 offset:57344
    v_mfma_f32_16x16x32_bf16 v[100:103], a[208:211], v[184:187], v[100:103]
    v_mfma_f32_16x16x32_bf16 v[104:107], a[204:207], v[188:191], v[104:107]
    ds_read_b128 v[172:175], v10 offset:58368
    v_mfma_f32_16x16x32_bf16 v[108:111], a[208:211], v[188:191], v[108:111]
    s_waitcnt lgkmcnt(2)
    v_mfma_f32_16x16x32_bf16 v[80:83], a[212:215], v[160:163], v[80:83]
    ds_read_b128 v[176:179], v9 offset:61440
    v_mfma_f32_16x16x32_bf16 v[84:87], a[216:219], v[160:163], v[84:87]
    buffer_load_dwordx4 v[240:243], v4, s[36:39], s48 offen offset:2048 sc1
    v_mfma_f32_16x16x32_bf16 v[88:91], a[212:215], v[164:167], v[88:91]
    ds_read_b128 v[180:183], v9 offset:62464
    v_mfma_f32_16x16x32_bf16 v[92:95], a[216:219], v[164:167], v[92:95]
    s_waitcnt lgkmcnt(2)
    v_mfma_f32_16x16x32_bf16 v[96:99], a[212:215], v[168:171], v[96:99]
    ds_read_b128 v[184:187], v10 offset:61440
    v_mfma_f32_16x16x32_bf16 v[100:103], a[216:219], v[168:171], v[100:103]
    v_mfma_f32_16x16x32_bf16 v[104:107], a[212:215], v[172:175], v[104:107]
    buffer_load_dwordx4 v[244:247], v4, s[36:39], s49 offen offset:2048 sc1
    ds_read_b128 v[188:191], v10 offset:62464
    v_mfma_f32_16x16x32_bf16 v[108:111], a[216:219], v[172:175], v[108:111]
    s_waitcnt lgkmcnt(2)
    v_mfma_f32_16x16x32_bf16 v[80:83], a[220:223], v[176:179], v[80:83]
    ds_read_b128 v[160:163], v11 offset:0
    v_mfma_f32_16x16x32_bf16 v[84:87], a[224:227], v[176:179], v[84:87]
    v_mfma_f32_16x16x32_bf16 v[88:91], a[220:223], v[180:183], v[88:91]
    ds_read_b128 v[164:167], v11 offset:1024
    v_mfma_f32_16x16x32_bf16 v[92:95], a[224:227], v[180:183], v[92:95]
    buffer_load_dwordx4 v[248:251], v4, s[36:39], s48 offen offset:3072 sc1
    s_waitcnt lgkmcnt(2)
    v_mfma_f32_16x16x32_bf16 v[96:99], a[220:223], v[184:187], v[96:99]
    ds_read_b128 v[168:171], v12 offset:0
    v_mfma_f32_16x16x32_bf16 v[100:103], a[224:227], v[184:187], v[100:103]
    v_mfma_f32_16x16x32_bf16 v[104:107], a[220:223], v[188:191], v[104:107]
    ds_read_b128 v[172:175], v12 offset:1024
    v_mfma_f32_16x16x32_bf16 v[108:111], a[224:227], v[188:191], v[108:111]
    s_waitcnt lgkmcnt(2)
    v_mfma_f32_16x16x32_bf16 v[80:83], a[228:231], v[160:163], v[80:83]
    buffer_load_dwordx4 v[252:255], v4, s[36:39], s49 offen offset:3072 sc1
    ds_read_b128 v[176:179], v11 offset:4096
    v_mfma_f32_16x16x32_bf16 v[84:87], a[232:235], v[160:163], v[84:87]
    v_mfma_f32_16x16x32_bf16 v[88:91], a[228:231], v[164:167], v[88:91]
    ds_read_b128 v[180:183], v11 offset:5120
    v_mfma_f32_16x16x32_bf16 v[92:95], a[232:235], v[164:167], v[92:95]
    s_waitcnt lgkmcnt(2)
    v_mfma_f32_16x16x32_bf16 v[96:99], a[228:231], v[168:171], v[96:99]
    ds_read_b128 v[184:187], v12 offset:4096
    v_mfma_f32_16x16x32_bf16 v[100:103], a[232:235], v[168:171], v[100:103]
    s_add_u32 s48, s87, 57344
    buffer_load_dwordx4 a[100:103], v4, s[36:39], s48 offen offset:0 sc1
    v_mfma_f32_16x16x32_bf16 v[104:107], a[228:231], v[172:175], v[104:107]
    ds_read_b128 v[188:191], v12 offset:5120
    v_mfma_f32_16x16x32_bf16 v[108:111], a[232:235], v[172:175], v[108:111]
    s_waitcnt lgkmcnt(2)
    v_mfma_f32_16x16x32_bf16 v[80:83], a[236:239], v[176:179], v[80:83]
    ds_read_b128 v[160:163], v11 offset:8192
    v_mfma_f32_16x16x32_bf16 v[84:87], a[240:243], v[176:179], v[84:87]
    v_mfma_f32_16x16x32_bf16 v[88:91], a[236:239], v[180:183], v[88:91]
    s_add_u32 s49, s88, 16384
    buffer_load_dwordx4 a[104:107], v4, s[36:39], s49 offen offset:0 sc1
    ds_read_b128 v[164:167], v11 offset:9216
    v_mfma_f32_16x16x32_bf16 v[92:95], a[240:243], v[180:183], v[92:95]
    s_waitcnt lgkmcnt(2)
    v_mfma_f32_16x16x32_bf16 v[96:99], a[236:239], v[184:187], v[96:99]
    ds_read_b128 v[168:171], v12 offset:8192
    v_mfma_f32_16x16x32_bf16 v[100:103], a[240:243], v[184:187], v[100:103]
    v_mfma_f32_16x16x32_bf16 v[104:107], a[236:239], v[188:191], v[104:107]
    ds_read_b128 v[172:175], v12 offset:9216
    v_mfma_f32_16x16x32_bf16 v[108:111], a[240:243], v[188:191], v[108:111]
    buffer_load_dwordx4 a[108:111], v4, s[36:39], s48 offen offset:1024 sc1
    s_waitcnt vmcnt(37) lgkmcnt(2)
    v_mfma_f32_16x16x32_bf16 v[80:83], a[244:247], v[160:163], v[80:83]
    ds_read_b128 v[176:179], v11 offset:12288
    v_mfma_f32_16x16x32_bf16 v[84:87], a[248:251], v[160:163], v[84:87]
    v_mfma_f32_16x16x32_bf16 v[88:91], a[244:247], v[164:167], v[88:91]
    ds_read_b128 v[180:183], v11 offset:13312
    v_mfma_f32_16x16x32_bf16 v[92:95], a[248:251], v[164:167], v[92:95]
    s_waitcnt lgkmcnt(2)
    v_mfma_f32_16x16x32_bf16 v[96:99], a[244:247], v[168:171], v[96:99]
    buffer_load_dwordx4 a[112:115], v4, s[36:39], s49 offen offset:1024 sc1
    ds_read_b128 v[184:187], v12 offset:12288
    v_mfma_f32_16x16x32_bf16 v[100:103], a[248:251], v[168:171], v[100:103]
    v_mfma_f32_16x16x32_bf16 v[104:107], a[244:247], v[172:175], v[104:107]
    ds_read_b128 v[188:191], v12 offset:13312
    v_mfma_f32_16x16x32_bf16 v[108:111], a[248:251], v[172:175], v[108:111]
    s_waitcnt vmcnt(36) lgkmcnt(2)
    v_mfma_f32_16x16x32_bf16 v[80:83], a[252:255], v[176:179], v[80:83]
    ds_read_b128 v[160:163], v9 offset:0
    v_mfma_f32_16x16x32_bf16 v[84:87], a[0:3], v[176:179], v[84:87]
    buffer_load_dwordx4 a[116:119], v4, s[36:39], s48 offen offset:2048 sc1
    v_mfma_f32_16x16x32_bf16 v[88:91], a[252:255], v[180:183], v[88:91]
    ds_read_b128 v[164:167], v9 offset:1024
    v_mfma_f32_16x16x32_bf16 v[92:95], a[0:3], v[180:183], v[92:95]
    s_waitcnt lgkmcnt(2)
    v_mfma_f32_16x16x32_bf16 v[96:99], a[252:255], v[184:187], v[96:99]
    ds_read_b128 v[168:171], v10 offset:0
    v_mfma_f32_16x16x32_bf16 v[100:103], a[0:3], v[184:187], v[100:103]
    v_mfma_f32_16x16x32_bf16 v[104:107], a[252:255], v[188:191], v[104:107]
    buffer_load_dwordx4 a[120:123], v4, s[36:39], s49 offen offset:2048 sc1
    ds_read_b128 v[172:175], v10 offset:1024
    v_mfma_f32_16x16x32_bf16 v[108:111], a[0:3], v[188:191], v[108:111]
    s_waitcnt vmcnt(36) lgkmcnt(2)
    v_mfma_f32_16x16x32_bf16 v[112:115], a[4:7], v[160:163], 0
    ds_read_b128 v[176:179], v9 offset:4096
    v_mfma_f32_16x16x32_bf16 v[128:131], a[8:11], v[160:163], 0
    v_mfma_f32_16x16x32_bf16 v[116:119], a[4:7], v[164:167], 0
    ds_read_b128 v[180:183], v9 offset:5120
    v_mfma_f32_16x16x32_bf16 v[132:135], a[8:11], v[164:167], 0
    buffer_load_dwordx4 a[124:127], v4, s[36:39], s48 offen offset:3072 sc1
    s_waitcnt lgkmcnt(2)
    v_mfma_f32_16x16x32_bf16 v[120:123], a[4:7], v[168:171], 0
    ds_read_b128 v[184:187], v10 offset:4096
    v_mfma_f32_16x16x32_bf16 v[124:127], a[4:7], v[172:175], 0
    ds_read_b128 v[188:191], v10 offset:5120
    s_waitcnt vmcnt(35) lgkmcnt(2)
    v_mfma_f32_16x16x32_bf16 v[112:115], a[12:15], v[176:179], v[112:115]
    ds_read_b128 v[160:163], v9 offset:8192
    v_mul_f32 v136, v80, v80
    v_mfma_f32_16x16x32_bf16 v[128:131], a[16:19], v[176:179], v[128:131]
    v_mul_f32 v137, v81, v81
    v_mul_f32 v138, v82, v82
    v_mfma_f32_16x16x32_bf16 v[116:119], a[12:15], v[180:183], v[116:119]
    buffer_load_dwordx4 a[128:131], v4, s[36:39], s49 offen offset:3072 sc1
    ds_read_b128 v[164:167], v9 offset:9216
    v_mul_f32 v139, v83, v83
    v_mfma_f32_16x16x32_bf16 v[132:135], a[16:19], v[180:183], v[132:135]
    v_mul_f32 v140, v84, v84
    v_mul_f32 v141, v85, v85
    s_waitcnt lgkmcnt(2)
    v_mfma_f32_16x16x32_bf16 v[120:123], a[12:15], v[184:187], v[120:123]
    ds_read_b128 v[168:171], v10 offset:8192
    v_mul_f32 v142, v86, v86
    v_mul_f32 v143, v87, v87
    v_mfma_f32_16x16x32_bf16 v[124:127], a[12:15], v[188:191], v[124:127]
    ds_read_b128 v[172:175], v10 offset:9216
    v_fma_f32 v136, v136, s94, v22
    v_fma_f32 v137, v137, s94, v22
    s_waitcnt vmcnt(34) lgkmcnt(2)
    v_mfma_f32_16x16x32_bf16 v[112:115], a[20:23], v[160:163], v[112:115]
    ds_read_b128 v[176:179], v9 offset:12288
    v_fma_f32 v138, v138, s94, v22
    v_mfma_f32_16x16x32_bf16 v[128:131], a[24:27], v[160:163], v[128:131]
    s_add_u32 s50, s13, 0
    buffer_load_dwordx4 a[132:135], v4, s[36:39], s50 offen offset:0 sc1
    v_fma_f32 v139, v139, s94, v22
    v_fma_f32 v140, v140, s94, v22
    v_mfma_f32_16x16x32_bf16 v[116:119], a[20:23], v[164:167], v[116:119]
    ds_read_b128 v[180:183], v9 offset:13312
    v_fma_f32 v141, v141, s94, v22
    v_mfma_f32_16x16x32_bf16 v[132:135], a[24:27], v[164:167], v[132:135]
    v_fma_f32 v142, v142, s94, v22
    v_fma_f32 v143, v143, s94, v22
    s_waitcnt lgkmcnt(2)
    v_mfma_f32_16x16x32_bf16 v[120:123], a[20:23], v[168:171], v[120:123]
    ds_read_b128 v[184:187], v10 offset:12288
    v_mul_f32 v136, v136, v80
    v_mul_f32 v137, v137, v81
    v_mfma_f32_16x16x32_bf16 v[124:127], a[20:23], v[172:175], v[124:127]
    ds_read_b128 v[188:191], v10 offset:13312
    v_mul_f32 v138, v138, v82
    v_mul_f32 v139, v139, v83
    buffer_load_dwordx4 a[136:139], v4, s[36:39], s50 offen offset:1024 sc1
    s_waitcnt vmcnt(34) lgkmcnt(2)
    v_mfma_f32_16x16x32_bf16 v[112:115], a[28:31], v[176:179], v[112:115]
    ds_read_b128 v[160:163], v9 offset:16384
    v_mul_f32 v140, v140, v84
    v_mfma_f32_16x16x32_bf16 v[128:131], a[32:35], v[176:179], v[128:131]
    v_mul_f32 v141, v141, v85
    v_mul_f32 v142, v142, v86
    v_mfma_f32_16x16x32_bf16 v[116:119], a[28:31], v[180:183], v[116:119]
    ds_read_b128 v[164:167], v9 offset:17408
    v_mul_f32 v143, v143, v87
    v_mfma_f32_16x16x32_bf16 v[132:135], a[32:35], v[180:183], v[132:135]
    v_exp_f32 v136, v136
    v_exp_f32 v137, v137
    s_waitcnt lgkmcnt(2)
    v_mfma_f32_16x16x32_bf16 v[120:123], a[28:31], v[184:187], v[120:123]
    buffer_load_dwordx4 a[140:143], v4, s[36:39], s50 offen offset:2048 sc1
    ds_read_b128 v[168:171], v10 offset:16384
    v_exp_f32 v138, v138
    v_exp_f32 v139, v139
    v_mfma_f32_16x16x32_bf16 v[124:127], a[28:31], v[188:191], v[124:127]
    ds_read_b128 v[172:175], v10 offset:17408
    v_exp_f32 v140, v140
    v_exp_f32 v141, v141
    s_waitcnt vmcnt(33) lgkmcnt(2)
    v_mfma_f32_16x16x32_bf16 v[112:115], a[36:39], v[160:163], v[112:115]
    ds_read_b128 v[176:179], v9 offset:20480
    v_exp_f32 v142, v142
    v_mfma_f32_16x16x32_bf16 v[128:131], a[40:43], v[160:163], v[128:131]
    buffer_load_dwordx4 a[144:147], v4, s[36:39], s50 offen offset:3072 sc1
    v_exp_f32 v143, v143
    v_add_f32 v136, 1.0, v136
    v_mfma_f32_16x16x32_bf16 v[116:119], a[36:39], v[164:167], v[116:119]
    ds_read_b128 v[180:183], v9 offset:21504
    v_add_f32 v137, 1.0, v137
    v_mfma_f32_16x16x32_bf16 v[132:135], a[40:43], v[164:167], v[132:135]
    v_add_f32 v138, 1.0, v138
    v_add_f32 v139, 1.0, v139
    s_waitcnt lgkmcnt(2)
    v_mfma_f32_16x16x32_bf16 v[120:123], a[36:39], v[168:171], v[120:123]
    ds_read_b128 v[184:187], v10 offset:20480
    v_add_f32 v140, 1.0, v140
    v_add_f32 v141, 1.0, v141
    v_mfma_f32_16x16x32_bf16 v[124:127], a[36:39], v[172:175], v[124:127]
    ds_read_b128 v[188:191], v10 offset:21504
    v_add_f32 v142, 1.0, v142
    v_add_f32 v143, 1.0, v143
    s_add_u32 s50, s13, 4096
    buffer_load_dwordx4 a[148:151], v4, s[36:39], s50 offen offset:0 sc1
    s_waitcnt vmcnt(33) lgkmcnt(2)
    v_mfma_f32_16x16x32_bf16 v[112:115], a[44:47], v[176:179], v[112:115]
    ds_read_b128 v[160:163], v9 offset:24576
    v_rcp_f32 v136, v136
    v_mfma_f32_16x16x32_bf16 v[128:131], a[48:51], v[176:179], v[128:131]
    v_rcp_f32 v137, v137
    v_rcp_f32 v138, v138
    v_mfma_f32_16x16x32_bf16 v[116:119], a[44:47], v[180:183], v[116:119]
    ds_read_b128 v[164:167], v9 offset:25600
    v_rcp_f32 v139, v139
    v_mfma_f32_16x16x32_bf16 v[132:135], a[48:51], v[180:183], v[132:135]
    buffer_load_dwordx4 a[152:155], v4, s[36:39], s50 offen offset:1024 sc1
    v_rcp_f32 v140, v140
    v_rcp_f32 v141, v141
    s_waitcnt lgkmcnt(2)
    v_mfma_f32_16x16x32_bf16 v[120:123], a[44:47], v[184:187], v[120:123]
    ds_read_b128 v[168:171], v10 offset:24576
    v_rcp_f32 v142, v142
    v_rcp_f32 v143, v143
    v_mfma_f32_16x16x32_bf16 v[124:127], a[44:47], v[188:191], v[124:127]
    ds_read_b128 v[172:175], v10 offset:25600
    v_mul_f32 v80, v80, v136
    v_mul_f32 v81, v81, v137
    s_waitcnt vmcnt(32) lgkmcnt(2)
    v_mfma_f32_16x16x32_bf16 v[112:115], a[52:55], v[160:163], v[112:115]
    ds_read_b128 v[176:179], v9 offset:28672
    v_mul_f32 v82, v82, v138
    v_mfma_f32_16x16x32_bf16 v[128:131], a[56:59], v[160:163], v[128:131]
    buffer_load_dwordx4 a[156:159], v4, s[36:39], s50 offen offset:2048 sc1
    v_mul_f32 v83, v83, v139
    v_mul_f32 v84, v84, v140
    v_mfma_f32_16x16x32_bf16 v[116:119], a[52:55], v[164:167], v[116:119]
    ds_read_b128 v[180:183], v9 offset:29696
    v_mul_f32 v85, v85, v141
    v_mfma_f32_16x16x32_bf16 v[132:135], a[56:59], v[164:167], v[132:135]
    v_mul_f32 v86, v86, v142
    v_mul_f32 v87, v87, v143
    s_waitcnt lgkmcnt(2)
    v_mfma_f32_16x16x32_bf16 v[120:123], a[52:55], v[168:171], v[120:123]
    ds_read_b128 v[184:187], v10 offset:28672
    v_cvt_pk_bf16_f32 v144, v80, v81
    v_cvt_pk_bf16_f32 v145, v82, v83
    v_mfma_f32_16x16x32_bf16 v[124:127], a[52:55], v[172:175], v[124:127]
    ds_read_b128 v[188:191], v10 offset:29696
    v_cvt_pk_bf16_f32 v146, v84, v85
    v_cvt_pk_bf16_f32 v147, v86, v87
    buffer_load_dwordx4 a[160:163], v4, s[36:39], s50 offen offset:3072 sc1
    s_waitcnt vmcnt(32) lgkmcnt(2)
    v_mfma_f32_16x16x32_bf16 v[112:115], a[60:63], v[176:179], v[112:115]
    ds_read_b128 v[160:163], v9 offset:32768
    buffer_store_dwordx4 v[144:147], v46, s[36:39], s8 offen sc1
    v_mfma_f32_16x16x32_bf16 v[128:131], a[64:67], v[176:179], v[128:131]
    v_mul_f32 v136, v88, v88
    v_mul_f32 v137, v89, v89
    v_mfma_f32_16x16x32_bf16 v[116:119], a[60:63], v[180:183], v[116:119]
    ds_read_b128 v[164:167], v9 offset:33792
    v_mul_f32 v138, v90, v90
    v_mfma_f32_16x16x32_bf16 v[132:135], a[64:67], v[180:183], v[132:135]
    v_mul_f32 v139, v91, v91
    v_mul_f32 v140, v92, v92
    s_waitcnt lgkmcnt(2)
    v_mfma_f32_16x16x32_bf16 v[120:123], a[60:63], v[184:187], v[120:123]
    s_add_u32 s50, s13, 8192
    buffer_load_dwordx4 a[164:167], v4, s[36:39], s50 offen offset:0 sc1
    ds_read_b128 v[168:171], v10 offset:32768
    v_mul_f32 v141, v93, v93
    v_mul_f32 v142, v94, v94
    v_mfma_f32_16x16x32_bf16 v[124:127], a[60:63], v[188:191], v[124:127]
    ds_read_b128 v[172:175], v10 offset:33792
    v_mul_f32 v143, v95, v95
    v_fma_f32 v136, v136, s94, v22
    s_waitcnt vmcnt(32) lgkmcnt(2)
    v_mfma_f32_16x16x32_bf16 v[112:115], a[68:71], v[160:163], v[112:115]
    ds_read_b128 v[176:179], v9 offset:36864
    v_fma_f32 v137, v137, s94, v22
    v_mfma_f32_16x16x32_bf16 v[128:131], a[72:75], v[160:163], v[128:131]
    v_fma_f32 v138, v138, s94, v22
    v_fma_f32 v139, v139, s94, v22
    v_mfma_f32_16x16x32_bf16 v[116:119], a[68:71], v[164:167], v[116:119]
    ds_read_b128 v[180:183], v9 offset:37888
    v_fma_f32 v140, v140, s94, v22
    v_mfma_f32_16x16x32_bf16 v[132:135], a[72:75], v[164:167], v[132:135]
    buffer_load_dwordx4 a[168:171], v4, s[36:39], s50 offen offset:1024 sc1
    v_fma_f32 v141, v141, s94, v22
    v_fma_f32 v142, v142, s94, v22
    s_waitcnt lgkmcnt(2)
    v_mfma_f32_16x16x32_bf16 v[120:123], a[68:71], v[168:171], v[120:123]
    ds_read_b128 v[184:187], v10 offset:36864
    v_fma_f32 v143, v143, s94, v22
    v_mul_f32 v136, v136, v88
    v_mfma_f32_16x16x32_bf16 v[124:127], a[68:71], v[172:175], v[124:127]
    ds_read_b128 v[188:191], v10 offset:37888
    v_mul_f32 v137, v137, v89
    v_mul_f32 v138, v138, v90
    s_waitcnt vmcnt(31) lgkmcnt(2)
    v_mfma_f32_16x16x32_bf16 v[112:115], a[76:79], v[176:179], v[112:115]
    ds_read_b128 v[160:163], v9 offset:40960
    v_mul_f32 v139, v139, v91
    v_mfma_f32_16x16x32_bf16 v[128:131], a[80:83], v[176:179], v[128:131]
    buffer_load_dwordx4 a[172:175], v4, s[36:39], s50 offen offset:2048 sc1
    v_mul_f32 v140, v140, v92
    v_mul_f32 v141, v141, v93
    v_mfma_f32_16x16x32_bf16 v[116:119], a[76:79], v[180:183], v[116:119]
    ds_read_b128 v[164:167], v9 offset:41984
    v_mul_f32 v142, v142, v94
    v_mfma_f32_16x16x32_bf16 v[132:135], a[80:83], v[180:183], v[132:135]
    v_mul_f32 v143, v143, v95
    v_exp_f32 v136, v136
    s_waitcnt lgkmcnt(2)
    v_mfma_f32_16x16x32_bf16 v[120:123], a[76:79], v[184:187], v[120:123]
    ds_read_b128 v[168:171], v10 offset:40960
    v_exp_f32 v137, v137
    v_exp_f32 v138, v138
    v_mfma_f32_16x16x32_bf16 v[124:127], a[76:79], v[188:191], v[124:127]
    buffer_load_dwordx4 a[176:179], v4, s[36:39], s50 offen offset:3072 sc1
    ds_read_b128 v[172:175], v10 offset:41984
    v_exp_f32 v139, v139
    v_exp_f32 v140, v140
    s_waitcnt vmcnt(31) lgkmcnt(2)
    v_mfma_f32_16x16x32_bf16 v[112:115], a[84:87], v[160:163], v[112:115]
    ds_read_b128 v[176:179], v9 offset:45056
    v_exp_f32 v141, v141
    v_mfma_f32_16x16x32_bf16 v[128:131], a[88:91], v[160:163], v[128:131]
    v_exp_f32 v142, v142
    v_exp_f32 v143, v143
    v_mfma_f32_16x16x32_bf16 v[116:119], a[84:87], v[164:167], v[116:119]
    ds_read_b128 v[180:183], v9 offset:46080
    v_add_f32 v136, 1.0, v136
    v_mfma_f32_16x16x32_bf16 v[132:135], a[88:91], v[164:167], v[132:135]
    s_add_u32 s50, s13, 12288
    buffer_load_dwordx4 a[180:183], v4, s[36:39], s50 offen offset:0 sc1
    v_add_f32 v137, 1.0, v137
    v_add_f32 v138, 1.0, v138
    s_waitcnt lgkmcnt(2)
    v_mfma_f32_16x16x32_bf16 v[120:123], a[84:87], v[168:171], v[120:123]
    ds_read_b128 v[184:187], v10 offset:45056
    v_add_f32 v139, 1.0, v139
    v_add_f32 v140, 1.0, v140
    v_mfma_f32_16x16x32_bf16 v[124:127], a[84:87], v[172:175], v[124:127]
    ds_read_b128 v[188:191], v10 offset:46080
    v_add_f32 v141, 1.0, v141
    v_add_f32 v142, 1.0, v142
    s_waitcnt vmcnt(30) lgkmcnt(2)
    v_mfma_f32_16x16x32_bf16 v[112:115], a[92:95], v[176:179], v[112:115]
    ds_read_b128 v[160:163], v9 offset:49152
    v_add_f32 v143, 1.0, v143
    v_mfma_f32_16x16x32_bf16 v[128:131], a[96:99], v[176:179], v[128:131]
    buffer_load_dwordx4 a[184:187], v4, s[36:39], s50 offen offset:1024 sc1
    v_rcp_f32 v136, v136
    v_rcp_f32 v137, v137
    v_mfma_f32_16x16x32_bf16 v[116:119], a[92:95], v[180:183], v[116:119]
    ds_read_b128 v[164:167], v9 offset:50176
    v_rcp_f32 v138, v138
    v_mfma_f32_16x16x32_bf16 v[132:135], a[96:99], v[180:183], v[132:135]
    v_rcp_f32 v139, v139
    v_rcp_f32 v140, v140
    s_waitcnt lgkmcnt(2)
    v_mfma_f32_16x16x32_bf16 v[120:123], a[92:95], v[184:187], v[120:123]
    ds_read_b128 v[168:171], v10 offset:49152
    v_rcp_f32 v141, v141
    v_rcp_f32 v142, v142
    buffer_load_dwordx4 a[188:191], v4, s[36:39], s50 offen offset:2048 sc1
    v_mfma_f32_16x16x32_bf16 v[124:127], a[92:95], v[188:191], v[124:127]
    ds_read_b128 v[172:175], v10 offset:50176
    v_rcp_f32 v143, v143
    v_mul_f32 v88, v88, v136
    s_waitcnt vmcnt(30) lgkmcnt(2)
    v_mfma_f32_16x16x32_bf16 v[112:115], v[224:227], v[160:163], v[112:115]
    ds_read_b128 v[176:179], v9 offset:53248
    v_mul_f32 v89, v89, v137
    v_mfma_f32_16x16x32_bf16 v[128:131], v[228:231], v[160:163], v[128:131]
    v_mul_f32 v90, v90, v138
    v_mul_f32 v91, v91, v139
    v_mfma_f32_16x16x32_bf16 v[116:119], v[224:227], v[164:167], v[116:119]
    ds_read_b128 v[180:183], v9 offset:54272
    v_mul_f32 v92, v92, v140
    v_mfma_f32_16x16x32_bf16 v[132:135], v[228:231], v[164:167], v[132:135]
    buffer_load_dwordx4 a[192:195], v4, s[36:39], s50 offen offset:3072 sc1
    v_mul_f32 v93, v93, v141
    v_mul_f32 v94, v94, v142
    s_waitcnt lgkmcnt(2)
    v_mfma_f32_16x16x32_bf16 v[120:123], v[224:227], v[168:171], v[120:123]
    ds_read_b128 v[184:187], v10 offset:53248
    v_mul_f32 v95, v95, v143
    v_cvt_pk_bf16_f32 v148, v88, v89
    v_mfma_f32_16x16x32_bf16 v[124:127], v[224:227], v[172:175], v[124:127]
    ds_read_b128 v[188:191], v10 offset:54272
    v_cvt_pk_bf16_f32 v149, v90, v91
    v_cvt_pk_bf16_f32 v150, v92, v93
    s_waitcnt vmcnt(29) lgkmcnt(2)
    v_mfma_f32_16x16x32_bf16 v[112:115], v[232:235], v[176:179], v[112:115]
    ds_read_b128 v[160:163], v9 offset:57344
    v_cvt_pk_bf16_f32 v151, v94, v95
    v_mfma_f32_16x16x32_bf16 v[128:131], v[236:239], v[176:179], v[128:131]
    s_add_u32 s50, s13, 16384
    buffer_load_dwordx4 a[196:199], v4, s[36:39], s50 offen offset:0 sc1
    buffer_store_dwordx4 v[148:151], v46, s[36:39], s9 offen sc1
    v_mul_f32 v136, v96, v96
    v_mfma_f32_16x16x32_bf16 v[116:119], v[232:235], v[180:183], v[116:119]
    ds_read_b128 v[164:167], v9 offset:58368
    v_mul_f32 v137, v97, v97
    v_mfma_f32_16x16x32_bf16 v[132:135], v[236:239], v[180:183], v[132:135]
    v_mul_f32 v138, v98, v98
    v_mul_f32 v139, v99, v99
    s_waitcnt lgkmcnt(2)
    v_mfma_f32_16x16x32_bf16 v[120:123], v[232:235], v[184:187], v[120:123]
    ds_read_b128 v[168:171], v10 offset:57344
    v_mul_f32 v140, v100, v100
    v_mul_f32 v141, v101, v101
    v_mfma_f32_16x16x32_bf16 v[124:127], v[232:235], v[188:191], v[124:127]
    ds_read_b128 v[172:175], v10 offset:58368
    v_mul_f32 v142, v102, v102
    v_mul_f32 v143, v103, v103
    s_waitcnt vmcnt(29) lgkmcnt(2)
    v_mfma_f32_16x16x32_bf16 v[112:115], v[240:243], v[160:163], v[112:115]
    buffer_load_dwordx4 a[200:203], v4, s[36:39], s50 offen offset:1024 sc1
    ds_read_b128 v[176:179], v9 offset:61440
    v_fma_f32 v136, v136, s94, v22
    v_mfma_f32_16x16x32_bf16 v[128:131], v[244:247], v[160:163], v[128:131]
    v_fma_f32 v137, v137, s94, v22
    v_fma_f32 v138, v138, s94, v22
    v_mfma_f32_16x16x32_bf16 v[116:119], v[240:243], v[164:167], v[116:119]
    ds_read_b128 v[180:183], v9 offset:62464
    v_fma_f32 v139, v139, s94, v22
    v_mfma_f32_16x16x32_bf16 v[132:135], v[244:247], v[164:167], v[132:135]
    v_fma_f32 v140, v140, s94, v22
    v_fma_f32 v141, v141, s94, v22
    s_waitcnt lgkmcnt(2)
    v_mfma_f32_16x16x32_bf16 v[120:123], v[240:243], v[168:171], v[120:123]
    ds_read_b128 v[184:187], v10 offset:61440
    v_fma_f32 v142, v142, s94, v22
    v_fma_f32 v143, v143, s94, v22
    v_mfma_f32_16x16x32_bf16 v[124:127], v[240:243], v[172:175], v[124:127]
    buffer_load_dwordx4 a[204:207], v4, s[36:39], s50 offen offset:2048 sc1
    ds_read_b128 v[188:191], v10 offset:62464
    v_mul_f32 v136, v136, v96
    v_mul_f32 v137, v137, v97
    s_waitcnt vmcnt(29) lgkmcnt(2)
    v_mfma_f32_16x16x32_bf16 v[112:115], v[248:251], v[176:179], v[112:115]
    ds_read_b128 v[160:163], v11 offset:0
    v_mul_f32 v138, v138, v98
    v_mfma_f32_16x16x32_bf16 v[128:131], v[252:255], v[176:179], v[128:131]
    v_mul_f32 v139, v139, v99
    v_mul_f32 v140, v140, v100
    v_mfma_f32_16x16x32_bf16 v[116:119], v[248:251], v[180:183], v[116:119]
    ds_read_b128 v[164:167], v11 offset:1024
    v_mul_f32 v141, v141, v101
    v_mfma_f32_16x16x32_bf16 v[132:135], v[252:255], v[180:183], v[132:135]
    buffer_load_dwordx4 a[208:211], v4, s[36:39], s50 offen offset:3072 sc1
    v_mul_f32 v142, v142, v102
    v_mul_f32 v143, v143, v103
    s_waitcnt lgkmcnt(2)
    v_mfma_f32_16x16x32_bf16 v[120:123], v[248:251], v[184:187], v[120:123]
    ds_read_b128 v[168:171], v12 offset:0
    v_exp_f32 v136, v136
    v_exp_f32 v137, v137
    v_mfma_f32_16x16x32_bf16 v[124:127], v[248:251], v[188:191], v[124:127]
    ds_read_b128 v[172:175], v12 offset:1024
    v_exp_f32 v138, v138
    v_exp_f32 v139, v139
    s_waitcnt vmcnt(28) lgkmcnt(2)
    v_mfma_f32_16x16x32_bf16 v[112:115], a[100:103], v[160:163], v[112:115]
    ds_read_b128 v[176:179], v11 offset:4096
    v_exp_f32 v140, v140
    v_mfma_f32_16x16x32_bf16 v[128:131], a[104:107], v[160:163], v[128:131]
    s_add_u32 s50, s13, 20480
    buffer_load_dwordx4 a[212:215], v4, s[36:39], s50 offen offset:0 sc1
    v_exp_f32 v141, v141
    v_exp_f32 v142, v142
    v_mfma_f32_16x16x32_bf16 v[116:119], a[100:103], v[164:167], v[116:119]
    ds_read_b128 v[180:183], v11 offset:5120
    v_exp_f32 v143, v143
    v_mfma_f32_16x16x32_bf16 v[132:135], a[104:107], v[164:167], v[132:135]
    v_add_f32 v136, 1.0, v136
    v_add_f32 v137, 1.0, v137
    s_waitcnt lgkmcnt(2)
    v_mfma_f32_16x16x32_bf16 v[120:123], a[100:103], v[168:171], v[120:123]
    ds_read_b128 v[184:187], v12 offset:4096
    v_add_f32 v138, 1.0, v138
    v_add_f32 v139, 1.0, v139
    v_mfma_f32_16x16x32_bf16 v[124:127], a[100:103], v[172:175], v[124:127]
    buffer_load_dwordx4 a[216:219], v4, s[36:39], s50 offen offset:1024 sc1
    ds_read_b128 v[188:191], v12 offset:5120
    v_add_f32 v140, 1.0, v140
    v_add_f32 v141, 1.0, v141
    s_waitcnt vmcnt(28) lgkmcnt(2)
    v_mfma_f32_16x16x32_bf16 v[112:115], a[108:111], v[176:179], v[112:115]
    ds_read_b128 v[160:163], v11 offset:8192
    v_add_f32 v142, 1.0, v142
    v_mfma_f32_16x16x32_bf16 v[128:131], a[112:115], v[176:179], v[128:131]
    v_add_f32 v143, 1.0, v143
    v_rcp_f32 v136, v136
    v_mfma_f32_16x16x32_bf16 v[116:119], a[108:111], v[180:183], v[116:119]
    ds_read_b128 v[164:167], v11 offset:9216
    v_rcp_f32 v137, v137
    v_mfma_f32_16x16x32_bf16 v[132:135], a[112:115], v[180:183], v[132:135]
    buffer_load_dwordx4 a[220:223], v4, s[36:39], s50 offen offset:2048 sc1
    v_rcp_f32 v138, v138
    v_rcp_f32 v139, v139
    s_waitcnt lgkmcnt(2)
    v_mfma_f32_16x16x32_bf16 v[120:123], a[108:111], v[184:187], v[120:123]
    ds_read_b128 v[168:171], v12 offset:8192
    v_rcp_f32 v140, v140
    v_rcp_f32 v141, v141
    v_mfma_f32_16x16x32_bf16 v[124:127], a[108:111], v[188:191], v[124:127]
    ds_read_b128 v[172:175], v12 offset:9216
    v_rcp_f32 v142, v142
    v_rcp_f32 v143, v143
    s_waitcnt vmcnt(27) lgkmcnt(2)
    v_mfma_f32_16x16x32_bf16 v[112:115], a[116:119], v[160:163], v[112:115]
    buffer_load_dwordx4 a[224:227], v4, s[36:39], s50 offen offset:3072 sc1
    ds_read_b128 v[176:179], v11 offset:12288
    v_mul_f32 v96, v96, v136
    v_mfma_f32_16x16x32_bf16 v[128:131], a[120:123], v[160:163], v[128:131]
    v_mul_f32 v97, v97, v137
    v_mul_f32 v98, v98, v138
    v_mfma_f32_16x16x32_bf16 v[116:119], a[116:119], v[164:167], v[116:119]
    ds_read_b128 v[180:183], v11 offset:13312
    v_mul_f32 v99, v99, v139
    v_mfma_f32_16x16x32_bf16 v[132:135], a[120:123], v[164:167], v[132:135]
    v_mul_f32 v100, v100, v140
    v_mul_f32 v101, v101, v141
    s_waitcnt lgkmcnt(2)
    v_mfma_f32_16x16x32_bf16 v[120:123], a[116:119], v[168:171], v[120:123]
    ds_read_b128 v[184:187], v12 offset:12288
    v_mul_f32 v102, v102, v142
    v_mul_f32 v103, v103, v143
    v_mfma_f32_16x16x32_bf16 v[124:127], a[116:119], v[172:175], v[124:127]
    s_add_u32 s50, s13, 24576
    buffer_load_dwordx4 a[228:231], v4, s[36:39], s50 offen offset:0 sc1
    ds_read_b128 v[188:191], v12 offset:13312
    v_cvt_pk_bf16_f32 v144, v96, v97
    v_cvt_pk_bf16_f32 v145, v98, v99
    s_waitcnt vmcnt(27) lgkmcnt(2)
    v_mfma_f32_16x16x32_bf16 v[112:115], a[124:127], v[176:179], v[112:115]
    v_cvt_pk_bf16_f32 v146, v100, v101
    v_mfma_f32_16x16x32_bf16 v[128:131], a[128:131], v[176:179], v[128:131]
    v_cvt_pk_bf16_f32 v147, v102, v103
    buffer_store_dwordx4 v[144:147], v46, s[36:39], s10 offen sc1
    v_mfma_f32_16x16x32_bf16 v[116:119], a[124:127], v[180:183], v[116:119]
    v_mul_f32 v136, v104, v104
    v_mfma_f32_16x16x32_bf16 v[132:135], a[128:131], v[180:183], v[132:135]
    buffer_load_dwordx4 a[232:235], v4, s[36:39], s50 offen offset:1024 sc1
    v_mul_f32 v137, v105, v105
    v_mul_f32 v138, v106, v106
    s_waitcnt lgkmcnt(0)
    v_mfma_f32_16x16x32_bf16 v[120:123], a[124:127], v[184:187], v[120:123]
    v_mul_f32 v139, v107, v107
    v_mul_f32 v140, v108, v108
    v_mfma_f32_16x16x32_bf16 v[124:127], a[124:127], v[188:191], v[124:127]
    v_mul_f32 v141, v109, v109
    v_mul_f32 v142, v110, v110
    v_mul_f32 v143, v111, v111
    v_fma_f32 v136, v136, s94, v22
    v_fma_f32 v137, v137, s94, v22
    v_fma_f32 v138, v138, s94, v22
    v_fma_f32 v139, v139, s94, v22
    v_fma_f32 v140, v140, s94, v22
    v_fma_f32 v141, v141, s94, v22
    v_fma_f32 v142, v142, s94, v22
    v_fma_f32 v143, v143, s94, v22
    v_mul_f32 v136, v136, v104
    v_mul_f32 v137, v137, v105
    v_mul_f32 v138, v138, v106
    buffer_load_dwordx4 a[236:239], v4, s[36:39], s50 offen offset:2048 sc1
    v_mul_f32 v139, v139, v107
    v_mul_f32 v140, v140, v108
    v_mul_f32 v141, v141, v109
    v_mul_f32 v142, v142, v110
    v_mul_f32 v143, v143, v111
    v_exp_f32 v136, v136
    v_exp_f32 v137, v137
    v_exp_f32 v138, v138
    v_exp_f32 v139, v139
    v_exp_f32 v140, v140
    v_exp_f32 v141, v141
    v_exp_f32 v142, v142
    v_exp_f32 v143, v143
    buffer_load_dwordx4 a[240:243], v4, s[36:39], s50 offen offset:3072 sc1
    v_add_f32 v136, 1.0, v136
    v_add_f32 v137, 1.0, v137
    v_add_f32 v138, 1.0, v138
    v_add_f32 v139, 1.0, v139
    v_add_f32 v140, 1.0, v140
    v_add_f32 v141, 1.0, v141
    v_add_f32 v142, 1.0, v142
    v_add_f32 v143, 1.0, v143
    v_rcp_f32 v136, v136
    v_rcp_f32 v137, v137
    v_rcp_f32 v138, v138
    v_rcp_f32 v139, v139
    v_rcp_f32 v140, v140
    v_rcp_f32 v141, v141
    s_add_u32 s50, s13, 28672
    buffer_load_dwordx4 a[244:247], v4, s[36:39], s50 offen offset:0 sc1
    v_rcp_f32 v142, v142
    v_rcp_f32 v143, v143
    v_mul_f32 v104, v104, v136
    v_mul_f32 v105, v105, v137
    v_mul_f32 v106, v106, v138
    v_mul_f32 v107, v107, v139
    v_mul_f32 v108, v108, v140
    v_mul_f32 v109, v109, v141
    v_mul_f32 v110, v110, v142
    v_mul_f32 v111, v111, v143
    v_cvt_pk_bf16_f32 v148, v104, v105
    v_cvt_pk_bf16_f32 v149, v106, v107
    v_cvt_pk_bf16_f32 v150, v108, v109
    v_cvt_pk_bf16_f32 v151, v110, v111
    buffer_store_dwordx4 v[148:151], v46, s[36:39], s11 offen sc1
    v_pk_mul_f32 v[80:81], v[112:113], v[112:113]
    v_pk_mul_f32 v[82:83], v[114:115], v[114:115]
    v_pk_mul_f32 v[84:85], v[116:117], v[116:117]
    v_pk_mul_f32 v[86:87], v[118:119], v[118:119]
    v_pk_mul_f32 v[88:89], v[120:121], v[120:121]
    v_pk_mul_f32 v[90:91], v[122:123], v[122:123]
    v_pk_mul_f32 v[92:93], v[124:125], v[124:125]
    v_pk_mul_f32 v[94:95], v[126:127], v[126:127]
    v_pk_mul_f32 v[96:97], v[128:129], v[128:129]
    v_pk_mul_f32 v[98:99], v[130:131], v[130:131]
    v_pk_mul_f32 v[100:101], v[132:133], v[132:133]
    v_pk_mul_f32 v[102:103], v[134:135], v[134:135]
    v_pk_fma_f32 v[80:81], v[80:81], s[94:95], v[22:23] op_sel_hi:[1,0,0]
    v_pk_fma_f32 v[82:83], v[82:83], s[94:95], v[22:23] op_sel_hi:[1,0,0]
    v_pk_fma_f32 v[84:85], v[84:85], s[94:95], v[22:23] op_sel_hi:[1,0,0]
    v_pk_fma_f32 v[86:87], v[86:87], s[94:95], v[22:23] op_sel_hi:[1,0,0]
    v_pk_fma_f32 v[88:89], v[88:89], s[94:95], v[22:23] op_sel_hi:[1,0,0]
    v_pk_fma_f32 v[90:91], v[90:91], s[94:95], v[22:23] op_sel_hi:[1,0,0]
    v_pk_fma_f32 v[92:93], v[92:93], s[94:95], v[22:23] op_sel_hi:[1,0,0]
    v_pk_fma_f32 v[94:95], v[94:95], s[94:95], v[22:23] op_sel_hi:[1,0,0]
    v_pk_fma_f32 v[96:97], v[96:97], s[94:95], v[22:23] op_sel_hi:[1,0,0]
    v_pk_fma_f32 v[98:99], v[98:99], s[94:95], v[22:23] op_sel_hi:[1,0,0]
    v_pk_fma_f32 v[100:101], v[100:101], s[94:95], v[22:23] op_sel_hi:[1,0,0]
    v_pk_fma_f32 v[102:103], v[102:103], s[94:95], v[22:23] op_sel_hi:[1,0,0]
    v_pk_mul_f32 v[80:81], v[80:81], v[112:113]
    v_pk_mul_f32 v[82:83], v[82:83], v[114:115]
    v_pk_mul_f32 v[84:85], v[84:85], v[116:117]
    v_pk_mul_f32 v[86:87], v[86:87], v[118:119]
    v_pk_mul_f32 v[88:89], v[88:89], v[120:121]
    v_pk_mul_f32 v[90:91], v[90:91], v[122:123]
    v_pk_mul_f32 v[92:93], v[92:93], v[124:125]
    v_pk_mul_f32 v[94:95], v[94:95], v[126:127]
    v_pk_mul_f32 v[96:97], v[96:97], v[128:129]
    v_pk_mul_f32 v[98:99], v[98:99], v[130:131]
    v_pk_mul_f32 v[100:101], v[100:101], v[132:133]
    v_pk_mul_f32 v[102:103], v[102:103], v[134:135]
    v_exp_f32 v80, v80
    v_exp_f32 v81, v81
    v_exp_f32 v82, v82
    v_exp_f32 v83, v83
    v_exp_f32 v84, v84
    v_exp_f32 v85, v85
    v_exp_f32 v86, v86
    v_exp_f32 v87, v87
    v_exp_f32 v88, v88
    v_exp_f32 v89, v89
    v_exp_f32 v90, v90
    v_exp_f32 v91, v91
    v_exp_f32 v92, v92
    v_exp_f32 v93, v93
    v_exp_f32 v94, v94
    v_exp_f32 v95, v95
    v_exp_f32 v96, v96
    v_exp_f32 v97, v97
    v_exp_f32 v98, v98
    v_exp_f32 v99, v99
    v_exp_f32 v100, v100
    v_exp_f32 v101, v101
    v_exp_f32 v102, v102
    v_exp_f32 v103, v103
    v_pk_add_f32 v[80:81], v[80:81], 1.0 op_sel_hi:[1,0]
    v_pk_add_f32 v[82:83], v[82:83], 1.0 op_sel_hi:[1,0]
    v_pk_add_f32 v[84:85], v[84:85], 1.0 op_sel_hi:[1,0]
    v_pk_add_f32 v[86:87], v[86:87], 1.0 op_sel_hi:[1,0]
    v_pk_add_f32 v[88:89], v[88:89], 1.0 op_sel_hi:[1,0]
    v_pk_add_f32 v[90:91], v[90:91], 1.0 op_sel_hi:[1,0]
    v_pk_add_f32 v[92:93], v[92:93], 1.0 op_sel_hi:[1,0]
    v_pk_add_f32 v[94:95], v[94:95], 1.0 op_sel_hi:[1,0]
    v_pk_add_f32 v[96:97], v[96:97], 1.0 op_sel_hi:[1,0]
    v_pk_add_f32 v[98:99], v[98:99], 1.0 op_sel_hi:[1,0]
    v_pk_add_f32 v[100:101], v[100:101], 1.0 op_sel_hi:[1,0]
    v_pk_add_f32 v[102:103], v[102:103], 1.0 op_sel_hi:[1,0]
    v_rcp_f32 v80, v80
    v_rcp_f32 v81, v81
    v_rcp_f32 v82, v82
    v_rcp_f32 v83, v83
    v_rcp_f32 v84, v84
    v_rcp_f32 v85, v85
    v_rcp_f32 v86, v86
    v_rcp_f32 v87, v87
    v_rcp_f32 v88, v88
    v_rcp_f32 v89, v89
    v_rcp_f32 v90, v90
    v_rcp_f32 v91, v91
    v_rcp_f32 v92, v92
    v_rcp_f32 v93, v93
    v_rcp_f32 v94, v94
    v_rcp_f32 v95, v95
    v_rcp_f32 v96, v96
    v_rcp_f32 v97, v97
    v_rcp_f32 v98, v98
    v_rcp_f32 v99, v99
    v_rcp_f32 v100, v100
    v_rcp_f32 v101, v101
    v_rcp_f32 v102, v102
    v_rcp_f32 v103, v103
    v_pk_mul_f32 v[112:113], v[112:113], v[80:81]
    v_pk_mul_f32 v[114:115], v[114:115], v[82:83]
    v_pk_mul_f32 v[116:117], v[116:117], v[84:85]
    v_pk_mul_f32 v[118:119], v[118:119], v[86:87]
    v_pk_mul_f32 v[120:121], v[120:121], v[88:89]
    v_pk_mul_f32 v[122:123], v[122:123], v[90:91]
    v_pk_mul_f32 v[124:125], v[124:125], v[92:93]
    v_pk_mul_f32 v[126:127], v[126:127], v[94:95]
    v_pk_mul_f32 v[128:129], v[128:129], v[96:97]
    v_pk_mul_f32 v[130:131], v[130:131], v[98:99]
    v_pk_mul_f32 v[132:133], v[132:133], v[100:101]
    v_pk_mul_f32 v[134:135], v[134:135], v[102:103]
    v_cvt_pk_bf16_f32 v80, v112, v113
    v_cvt_pk_bf16_f32 v81, v114, v115
    v_cvt_pk_bf16_f32 v82, v116, v117
    v_cvt_pk_bf16_f32 v83, v118, v119
    v_cvt_pk_bf16_f32 v84, v120, v121
    v_cvt_pk_bf16_f32 v85, v122, v123
    v_cvt_pk_bf16_f32 v86, v124, v125
    v_cvt_pk_bf16_f32 v87, v126, v127
    v_cvt_pk_bf16_f32 v88, v128, v129
    v_cvt_pk_bf16_f32 v89, v130, v131
    v_cvt_pk_bf16_f32 v90, v132, v133
    v_cvt_pk_bf16_f32 v91, v134, v135
    v_add_u32 v9, s12, v13
    v_add_u32 v13, s30, v13
    buffer_store_dwordx2 v[80:81], v13, s[36:39], s8 offen sc1
    buffer_store_dwordx2 v[82:83], v13, s[36:39], s9 offen sc1
    buffer_store_dwordx2 v[84:85], v13, s[36:39], s10 offen sc1
    buffer_store_dwordx2 v[86:87], v13, s[36:39], s11 offen sc1
    buffer_store_dwordx2 v[88:89], v9, s[36:39], s8 offen sc1
    buffer_store_dwordx2 v[90:91], v9, s[36:39], s9 offen sc1
    s_cmp_eq_u32 s60, 0
    s_cbranch_scc1 L_alt_30
    v_and_b32 v17, 3, v2
    v_mul_u32_u24 v13, 4160, v17
    v_lshrrev_b32 v17, 2, v2
    v_add_u32 v17, v17, v3
    v_lshl_add_u32 v13, v17, 4, v13
    s_add_u32 s70, s62, 192
    v_add_u32 v13, s70, v13
    v_and_b32 v17, 1, v2
    v_mul_u32_u24 v17, 4128, v17
    s_add_u32 s70, s62, 16640
    v_add_u32 v17, s70, v17
    v_add_u32 v16, 4096, v17
    v_lshrrev_b32 v18, 1, v2
    v_lshlrev_b32 v18, 6, v18
    v_sub_u32 v17, v17, v18
    v_lshl_add_u32 v17, v3, 4, v17
    v_add_u32 v14, 640, v17
    v_add_u32 v15, 3584, v14
    v_min_u32 v15, v15, v16
    ds_read_b128 v[108:111], v13 offset:3584
    ds_read_b128 v[140:143], v14 offset:0
    ds_read_b128 v[104:107], v13 offset:3072
    buffer_load_dwordx4 a[248:251], v4, s[36:39], s50 offen offset:1024 sc1
    ds_read_b128 v[136:139], v14 offset:512
    ds_read_b128 v[100:103], v13 offset:2560
    ds_read_b128 v[132:135], v14 offset:1024
    ds_read_b128 v[96:99], v13 offset:2048
    ds_read_b128 v[128:131], v14 offset:1536
    ds_read_b128 v[92:95], v13 offset:1536
    ds_read_b128 v[124:127], v14 offset:2048
    ds_read_b128 v[88:91], v13 offset:1024
    ds_read_b128 v[120:123], v14 offset:2560
    ds_read_b128 v[84:87], v13 offset:512
    ds_read_b128 v[116:119], v14 offset:3072
    ds_read_b128 v[80:83], v13 offset:0
    ds_read_b128 v[112:115], v15
    s_waitcnt lgkmcnt(7)
    v_mfma_f32_16x16x32_bf16 v[76:79], v[92:95], v[128:131], v[76:79]
    v_add_u32 v15, 3648, v14
    s_waitcnt lgkmcnt(6)
    v_mfma_f32_16x16x32_bf16 v[76:79], v[96:99], v[124:127], v[76:79]
    buffer_load_dwordx4 a[252:255], v4, s[36:39], s50 offen offset:2048 sc1
    v_min_u32 v15, v15, v16
    s_waitcnt lgkmcnt(5)
    v_mfma_f32_16x16x32_bf16 v[76:79], v[88:91], v[132:135], v[76:79]
    s_waitcnt lgkmcnt(4)
    v_mfma_f32_16x16x32_bf16 v[76:79], v[100:103], v[120:123], v[76:79]
    s_waitcnt lgkmcnt(3)
    v_mfma_f32_16x16x32_bf16 v[76:79], v[84:87], v[136:139], v[76:79]
    s_waitcnt lgkmcnt(2)
    v_mfma_f32_16x16x32_bf16 v[76:79], v[104:107], v[116:119], v[76:79]
    s_waitcnt lgkmcnt(1)
    v_mfma_f32_16x16x32_bf16 v[76:79], v[80:83], v[140:143], v[76:79]
    buffer_load_dwordx4 a[0:3], v4, s[36:39], s50 offen offset:3072 sc1
    s_waitcnt lgkmcnt(0)
    v_mfma_f32_16x16x32_bf16 v[76:79], v[108:111], v[112:115], v[76:79]
    ds_read_b128 v[108:111], v13 offset:3648
    ds_read_b128 v[140:143], v14 offset:64
    v_mfma_f32_16x16x32_bf16 v[72:75], v[80:83], v[136:139], v[72:75]
    v_mfma_f32_16x16x32_bf16 v[72:75], v[84:87], v[132:135], v[72:75]
    v_mfma_f32_16x16x32_bf16 v[72:75], v[88:91], v[128:131], v[72:75]
    v_mfma_f32_16x16x32_bf16 v[72:75], v[92:95], v[124:127], v[72:75]
    s_add_u32 s50, s13, 32768
    buffer_load_dwordx4 a[4:7], v4, s[36:39], s50 offen offset:0 sc1
    v_mfma_f32_16x16x32_bf16 v[72:75], v[96:99], v[120:123], v[72:75]
    v_mfma_f32_16x16x32_bf16 v[72:75], v[100:103], v[116:119], v[72:75]
    v_mfma_f32_16x16x32_bf16 v[72:75], v[104:107], v[112:115], v[72:75]
    ds_read_b128 v[104:107], v13 offset:3136
    ds_read_b128 v[136:139], v14 offset:576
    v_mfma_f32_16x16x32_bf16 v[68:71], v[80:83], v[132:135], v[68:71]
    v_mfma_f32_16x16x32_bf16 v[68:71], v[84:87], v[128:131], v[68:71]
    buffer_load_dwordx4 a[8:11], v4, s[36:39], s50 offen offset:1024 sc1
    v_mfma_f32_16x16x32_bf16 v[68:71], v[88:91], v[124:127], v[68:71]
    v_mfma_f32_16x16x32_bf16 v[68:71], v[92:95], v[120:123], v[68:71]
    v_mfma_f32_16x16x32_bf16 v[68:71], v[96:99], v[116:119], v[68:71]
    v_mfma_f32_16x16x32_bf16 v[68:71], v[100:103], v[112:115], v[68:71]
    ds_read_b128 v[100:103], v13 offset:2624
    ds_read_b128 v[132:135], v14 offset:1088
    v_mfma_f32_16x16x32_bf16 v[64:67], v[80:83], v[128:131], v[64:67]
    buffer_load_dwordx4 a[12:15], v4, s[36:39], s50 offen offset:2048 sc1
    v_mfma_f32_16x16x32_bf16 v[64:67], v[84:87], v[124:127], v[64:67]
    v_mfma_f32_16x16x32_bf16 v[64:67], v[88:91], v[120:123], v[64:67]
    v_mfma_f32_16x16x32_bf16 v[64:67], v[92:95], v[116:119], v[64:67]
    v_mfma_f32_16x16x32_bf16 v[64:67], v[96:99], v[112:115], v[64:67]
    ds_read_b128 v[96:99], v13 offset:2112
    ds_read_b128 v[128:131], v14 offset:1600
    v_mfma_f32_16x16x32_bf16 v[60:63], v[80:83], v[124:127], v[60:63]
    buffer_load_dwordx4 a[16:19], v4, s[36:39], s50 offen offset:3072 sc1
    v_mfma_f32_16x16x32_bf16 v[60:63], v[84:87], v[120:123], v[60:63]
    v_mfma_f32_16x16x32_bf16 v[60:63], v[88:91], v[116:119], v[60:63]
    v_mfma_f32_16x16x32_bf16 v[60:63], v[92:95], v[112:115], v[60:63]
    ds_read_b128 v[92:95], v13 offset:1600
    ds_read_b128 v[124:127], v14 offset:2112
    v_mfma_f32_16x16x32_bf16 v[56:59], v[80:83], v[120:123], v[56:59]
    v_mfma_f32_16x16x32_bf16 v[56:59], v[84:87], v[116:119], v[56:59]
    s_add_u32 s50, s13, 36864
    buffer_load_dwordx4 a[20:23], v4, s[36:39], s50 offen offset:0 sc1
    v_mfma_f32_16x16x32_bf16 v[56:59], v[88:91], v[112:115], v[56:59]
    ds_read_b128 v[88:91], v13 offset:1088
    ds_read_b128 v[120:123], v14 offset:2624
    v_mfma_f32_16x16x32_bf16 v[52:55], v[80:83], v[116:119], v[52:55]
    v_mfma_f32_16x16x32_bf16 v[52:55], v[84:87], v[112:115], v[52:55]
    ds_read_b128 v[84:87], v13 offset:576
    ds_read_b128 v[116:119], v14 offset:3136
    v_mfma_f32_16x16x32_bf16 v[48:51], v[80:83], v[112:115], v[48:51]
    ds_read_b128 v[80:83], v13 offset:64
    ds_read_b128 v[112:115], v15
    s_waitcnt vmcnt(8)
    s_barrier
    s_cmp_lg_u32 s58, 0
    s_cbranch_scc1 L_nofl_32
    v_mov_b32 v10, s64
    v_mov_b32 v11, s65
    v_mov_b32 v12, 0x2000
    s_mov_b64 exec, 1
    buffer_store_dwordx2 v[10:11], v12, s[36:39], s24 offen sc1
    s_mov_b64 exec, -1
L_nofl_32:
    s_waitcnt lgkmcnt(7)
    v_mfma_f32_16x16x32_bf16 v[76:79], v[92:95], v[128:131], v[76:79]
    buffer_load_dwordx4 a[24:27], v4, s[36:39], s50 offen offset:1024 sc1
    v_add_u32 v15, 3712, v14
    s_waitcnt lgkmcnt(6)
    v_mfma_f32_16x16x32_bf16 v[76:79], v[96:99], v[124:127], v[76:79]
    v_min_u32 v15, v15, v16
    s_waitcnt lgkmcnt(5)
    v_mfma_f32_16x16x32_bf16 v[76:79], v[88:91], v[132:135], v[76:79]
    s_waitcnt lgkmcnt(4)
    v_mfma_f32_16x16x32_bf16 v[76:79], v[100:103], v[120:123], v[76:79]
    s_waitcnt lgkmcnt(3)
    v_mfma_f32_16x16x32_bf16 v[76:79], v[84:87], v[136:139], v[76:79]
    s_waitcnt lgkmcnt(2)
    v_mfma_f32_16x16x32_bf16 v[76:79], v[104:107], v[116:119], v[76:79]
    buffer_load_dwordx4 a[28:31], v4, s[36:39], s50 offen offset:2048 sc1
    s_waitcnt lgkmcnt(1)
    v_mfma_f32_16x16x32_bf16 v[76:79], v[80:83], v[140:143], v[76:79]
    s_waitcnt lgkmcnt(0)
    v_mfma_f32_16x16x32_bf16 v[76:79], v[108:111], v[112:115], v[76:79]
    ds_read_b128 v[108:111], v13 offset:3712
    ds_read_b128 v[140:143], v14 offset:128
    v_mfma_f32_16x16x32_bf16 v[72:75], v[80:83], v[136:139], v[72:75]
    v_mfma_f32_16x16x32_bf16 v[72:75], v[84:87], v[132:135], v[72:75]
    v_mfma_f32_16x16x32_bf16 v[72:75], v[88:91], v[128:131], v[72:75]
    buffer_load_dwordx4 a[32:35], v4, s[36:39], s50 offen offset:3072 sc1
    v_mfma_f32_16x16x32_bf16 v[72:75], v[92:95], v[124:127], v[72:75]
    v_mfma_f32_16x16x32_bf16 v[72:75], v[96:99], v[120:123], v[72:75]
    v_mfma_f32_16x16x32_bf16 v[72:75], v[100:103], v[116:119], v[72:75]
    v_mfma_f32_16x16x32_bf16 v[72:75], v[104:107], v[112:115], v[72:75]
    ds_read_b128 v[104:107], v13 offset:3200
    ds_read_b128 v[136:139], v14 offset:640
    v_mfma_f32_16x16x32_bf16 v[68:71], v[80:83], v[132:135], v[68:71]
    s_add_u32 s50, s13, 40960
    buffer_load_dwordx4 a[36:39], v4, s[36:39], s50 offen offset:0 sc1
    v_mfma_f32_16x16x32_bf16 v[68:71], v[84:87], v[128:131], v[68:71]
    v_mfma_f32_16x16x32_bf16 v[68:71], v[88:91], v[124:127], v[68:71]
    v_mfma_f32_16x16x32_bf16 v[68:71], v[92:95], v[120:123], v[68:71]
    v_mfma_f32_16x16x32_bf16 v[68:71], v[96:99], v[116:119], v[68:71]
    v_mfma_f32_16x16x32_bf16 v[68:71], v[100:103], v[112:115], v[68:71]
    buffer_load_dwordx4 a[40:43], v4, s[36:39], s50 offen offset:1024 sc1
    ds_read_b128 v[100:103], v13 offset:2688
    ds_read_b128 v[132:135], v14 offset:1152
    v_mfma_f32_16x16x32_bf16 v[64:67], v[80:83], v[128:131], v[64:67]
    v_mfma_f32_16x16x32_bf16 v[64:67], v[84:87], v[124:127], v[64:67]
    v_mfma_f32_16x16x32_bf16 v[64:67], v[88:91], v[120:123], v[64:67]
    v_mfma_f32_16x16x32_bf16 v[64:67], v[92:95], v[116:119], v[64:67]
    v_mfma_f32_16x16x32_bf16 v[64:67], v[96:99], v[112:115], v[64:67]
    buffer_load_dwordx4 a[44:47], v4, s[36:39], s50 offen offset:2048 sc1
    ds_read_b128 v[96:99], v13 offset:2176
    ds_read_b128 v[128:131], v14 offset:1664
    v_mfma_f32_16x16x32_bf16 v[60:63], v[80:83], v[124:127], v[60:63]
    v_mfma_f32_16x16x32_bf16 v[60:63], v[84:87], v[120:123], v[60:63]
    v_mfma_f32_16x16x32_bf16 v[60:63], v[88:91], v[116:119], v[60:63]
    v_mfma_f32_16x16x32_bf16 v[60:63], v[92:95], v[112:115], v[60:63]
    ds_read_b128 v[92:95], v13 offset:1664
    ds_read_b128 v[124:127], v14 offset:2176
    v_mfma_f32_16x16x32_bf16 v[56:59], v[80:83], v[120:123], v[56:59]
    buffer_load_dwordx4 a[48:51], v4, s[36:39], s50 offen offset:3072 sc1
    v_mfma_f32_16x16x32_bf16 v[56:59], v[84:87], v[116:119], v[56:59]
    v_mfma_f32_16x16x32_bf16 v[56:59], v[88:91], v[112:115], v[56:59]
    ds_read_b128 v[88:91], v13 offset:1152
    ds_read_b128 v[120:123], v14 offset:2688
    v_mfma_f32_16x16x32_bf16 v[52:55], v[80:83], v[116:119], v[52:55]
    v_mfma_f32_16x16x32_bf16 v[52:55], v[84:87], v[112:115], v[52:55]
    ds_read_b128 v[84:87], v13 offset:640
    ds_read_b128 v[116:119], v14 offset:3200
    v_mfma_f32_16x16x32_bf16 v[48:51], v[80:83], v[112:115], v[48:51]
    s_add_u32 s50, s13, 45056
    buffer_load_dwordx4 a[52:55], v4, s[36:39], s50 offen offset:0 sc1
    ds_read_b128 v[80:83], v13 offset:128
    ds_read_b128 v[112:115], v15
    s_waitcnt lgkmcnt(7)
    v_mfma_f32_16x16x32_bf16 v[76:79], v[92:95], v[128:131], v[76:79]
    v_add_u32 v15, 3776, v14
    s_waitcnt lgkmcnt(6)
    v_mfma_f32_16x16x32_bf16 v[76:79], v[96:99], v[124:127], v[76:79]
    v_min_u32 v15, v15, v16
    s_waitcnt lgkmcnt(5)
    v_mfma_f32_16x16x32_bf16 v[76:79], v[88:91], v[132:135], v[76:79]
    s_waitcnt lgkmcnt(4)
    v_mfma_f32_16x16x32_bf16 v[76:79], v[100:103], v[120:123], v[76:79]
    s_waitcnt lgkmcnt(3)
    v_mfma_f32_16x16x32_bf16 v[76:79], v[84:87], v[136:139], v[76:79]
    buffer_load_dwordx4 a[56:59], v4, s[36:39], s50 offen offset:1024 sc1
    s_waitcnt lgkmcnt(2)
    v_mfma_f32_16x16x32_bf16 v[76:79], v[104:107], v[116:119], v[76:79]
    s_waitcnt lgkmcnt(1)
    v_mfma_f32_16x16x32_bf16 v[76:79], v[80:83], v[140:143], v[76:79]
    s_waitcnt lgkmcnt(0)
    v_mfma_f32_16x16x32_bf16 v[76:79], v[108:111], v[112:115], v[76:79]
    ds_read_b128 v[108:111], v13 offset:3776
    ds_read_b128 v[140:143], v14 offset:192
    v_mfma_f32_16x16x32_bf16 v[72:75], v[80:83], v[136:139], v[72:75]
    v_mfma_f32_16x16x32_bf16 v[72:75], v[84:87], v[132:135], v[72:75]
    buffer_load_dwordx4 a[60:63], v4, s[36:39], s50 offen offset:2048 sc1
    v_mfma_f32_16x16x32_bf16 v[72:75], v[88:91], v[128:131], v[72:75]
    v_mfma_f32_16x16x32_bf16 v[72:75], v[92:95], v[124:127], v[72:75]
    v_mfma_f32_16x16x32_bf16 v[72:75], v[96:99], v[120:123], v[72:75]
    v_mfma_f32_16x16x32_bf16 v[72:75], v[100:103], v[116:119], v[72:75]
    v_mfma_f32_16x16x32_bf16 v[72:75], v[104:107], v[112:115], v[72:75]
    buffer_load_dwordx4 a[64:67], v4, s[36:39], s50 offen offset:3072 sc1
    ds_read_b128 v[104:107], v13 offset:3264
    ds_read_b128 v[136:139], v14 offset:704
    v_mfma_f32_16x16x32_bf16 v[68:71], v[80:83], v[132:135], v[68:71]
    v_mfma_f32_16x16x32_bf16 v[68:71], v[84:87], v[128:131], v[68:71]
    v_mfma_f32_16x16x32_bf16 v[68:71], v[88:91], v[124:127], v[68:71]
    v_mfma_f32_16x16x32_bf16 v[68:71], v[92:95], v[120:123], v[68:71]
    v_mfma_f32_16x16x32_bf16 v[68:71], v[96:99], v[116:119], v[68:71]
    s_add_u32 s50, s13, 49152
    buffer_load_dwordx4 a[68:71], v4, s[36:39], s50 offen offset:0 sc1
    v_mfma_f32_16x16x32_bf16 v[68:71], v[100:103], v[112:115], v[68:71]
    ds_read_b128 v[100:103], v13 offset:2752
    ds_read_b128 v[132:135], v14 offset:1216
    v_mfma_f32_16x16x32_bf16 v[64:67], v[80:83], v[128:131], v[64:67]
    v_mfma_f32_16x16x32_bf16 v[64:67], v[84:87], v[124:127], v[64:67]
    v_mfma_f32_16x16x32_bf16 v[64:67], v[88:91], v[120:123], v[64:67]
    v_mfma_f32_16x16x32_bf16 v[64:67], v[92:95], v[116:119], v[64:67]
    buffer_load_dwordx4 a[72:75], v4, s[36:39], s50 offen offset:1024 sc1
    v_mfma_f32_16x16x32_bf16 v[64:67], v[96:99], v[112:115], v[64:67]
    ds_read_b128 v[96:99], v13 offset:2240
    ds_read_b128 v[128:131], v14 offset:1728
    v_mfma_f32_16x16x32_bf16 v[60:63], v[80:83], v[124:127], v[60:63]
    v_mfma_f32_16x16x32_bf16 v[60:63], v[84:87], v[120:123], v[60:63]
    v_mfma_f32_16x16x32_bf16 v[60:63], v[88:91], v[116:119], v[60:63]
    v_mfma_f32_16x16x32_bf16 v[60:63], v[92:95], v[112:115], v[60:63]
    buffer_load_dwordx4 a[76:79], v4, s[36:39], s50 offen offset:2048 sc1
    ds_read_b128 v[92:95], v13 offset:1728
    ds_read_b128 v[124:127], v14 offset:2240
    v_mfma_f32_16x16x32_bf16 v[56:59], v[80:83], v[120:123], v[56:59]
    v_mfma_f32_16x16x32_bf16 v[56:59], v[84:87], v[116:119], v[56:59]
    v_mfma_f32_16x16x32_bf16 v[56:59], v[88:91], v[112:115], v[56:59]
    ds_read_b128 v[88:91], v13 offset:1216
    ds_read_b128 v[120:123], v14 offset:2752
    v_mfma_f32_16x16x32_bf16 v[52:55], v[80:83], v[116:119], v[52:55]
    v_mfma_f32_16x16x32_bf16 v[52:55], v[84:87], v[112:115], v[52:55]
    buffer_load_dwordx4 a[80:83], v4, s[36:39], s50 offen offset:3072 sc1
    ds_read_b128 v[84:87], v13 offset:704
    ds_read_b128 v[116:119], v14 offset:3264
    v_mfma_f32_16x16x32_bf16 v[48:51], v[80:83], v[112:115], v[48:51]
    ds_read_b128 v[80:83], v13 offset:192
    ds_read_b128 v[112:115], v15
    s_waitcnt lgkmcnt(7)
    v_mfma_f32_16x16x32_bf16 v[76:79], v[92:95], v[128:131], v[76:79]
    v_add_u32 v15, 3840, v14
    s_waitcnt lgkmcnt(6)
    v_mfma_f32_16x16x32_bf16 v[76:79], v[96:99], v[124:127], v[76:79]
    v_min_u32 v15, v15, v16
    s_waitcnt lgkmcnt(5)
    v_mfma_f32_16x16x32_bf16 v[76:79], v[88:91], v[132:135], v[76:79]
    s_waitcnt lgkmcnt(4)
    v_mfma_f32_16x16x32_bf16 v[76:79], v[100:103], v[120:123], v[76:79]
    s_add_u32 s50, s13, 53248
    buffer_load_dwordx4 a[84:87], v4, s[36:39], s50 offen offset:0 sc1
    s_waitcnt lgkmcnt(3)
    v_mfma_f32_16x16x32_bf16 v[76:79], v[84:87], v[136:139], v[76:79]
    s_waitcnt lgkmcnt(2)
    v_mfma_f32_16x16x32_bf16 v[76:79], v[104:107], v[116:119], v[76:79]
    s_waitcnt lgkmcnt(1)
    v_mfma_f32_16x16x32_bf16 v[76:79], v[80:83], v[140:143], v[76:79]
    s_waitcnt lgkmcnt(0)
    v_mfma_f32_16x16x32_bf16 v[76:79], v[108:111], v[112:115], v[76:79]
    ds_read_b128 v[108:111], v13 offset:3840
    ds_read_b128 v[140:143], v14 offset:256
    v_mfma_f32_16x16x32_bf16 v[72:75], v[80:83], v[136:139], v[72:75]
    buffer_load_dwordx4 a[88:91], v4, s[36:39], s50 offen offset:1024 sc1
    v_mfma_f32_16x16x32_bf16 v[72:75], v[84:87], v[132:135], v[72:75]
    v_mfma_f32_16x16x32_bf16 v[72:75], v[88:91], v[128:131], v[72:75]
    v_mfma_f32_16x16x32_bf16 v[72:75], v[92:95], v[124:127], v[72:75]
    v_mfma_f32_16x16x32_bf16 v[72:75], v[96:99], v[120:123], v[72:75]
    v_mfma_f32_16x16x32_bf16 v[72:75], v[100:103], v[116:119], v[72:75]
    buffer_load_dwordx4 a[92:95], v4, s[36:39], s50 offen offset:2048 sc1
    v_mfma_f32_16x16x32_bf16 v[72:75], v[104:107], v[112:115], v[72:75]
    ds_read_b128 v[104:107], v13 offset:3328
    ds_read_b128 v[136:139], v14 offset:768
    v_mfma_f32_16x16x32_bf16 v[68:71], v[80:83], v[132:135], v[68:71]
    v_mfma_f32_16x16x32_bf16 v[68:71], v[84:87], v[128:131], v[68:71]
    v_mfma_f32_16x16x32_bf16 v[68:71], v[88:91], v[124:127], v[68:71]
    v_mfma_f32_16x16x32_bf16 v[68:71], v[92:95], v[120:123], v[68:71]
    buffer_load_dwordx4 a[96:99], v4, s[36:39], s50 offen offset:3072 sc1
    v_mfma_f32_16x16x32_bf16 v[68:71], v[96:99], v[116:119], v[68:71]
    v_mfma_f32_16x16x32_bf16 v[68:71], v[100:103], v[112:115], v[68:71]
    ds_read_b128 v[100:103], v13 offset:2816
    ds_read_b128 v[132:135], v14 offset:1280
    v_mfma_f32_16x16x32_bf16 v[64:67], v[80:83], v[128:131], v[64:67]
    v_mfma_f32_16x16x32_bf16 v[64:67], v[84:87], v[124:127], v[64:67]
    v_mfma_f32_16x16x32_bf16 v[64:67], v[88:91], v[120:123], v[64:67]
    s_add_u32 s50, s13, 57344
    buffer_load_dwordx4 v[224:227], v4, s[36:39], s50 offen offset:0 sc1
    v_mfma_f32_16x16x32_bf16 v[64:67], v[92:95], v[116:119], v[64:67]
    v_mfma_f32_16x16x32_bf16 v[64:67], v[96:99], v[112:115], v[64:67]
    ds_read_b128 v[96:99], v13 offset:2304
    ds_read_b128 v[128:131], v14 offset:1792
    v_mfma_f32_16x16x32_bf16 v[60:63], v[80:83], v[124:127], v[60:63]
    v_mfma_f32_16x16x32_bf16 v[60:63], v[84:87], v[120:123], v[60:63]
    v_mfma_f32_16x16x32_bf16 v[60:63], v[88:91], v[116:119], v[60:63]
    buffer_load_dwordx4 v[228:231], v4, s[36:39], s50 offen offset:1024 sc1
    v_mfma_f32_16x16x32_bf16 v[60:63], v[92:95], v[112:115], v[60:63]
    ds_read_b128 v[92:95], v13 offset:1792
    ds_read_b128 v[124:127], v14 offset:2304
    v_mfma_f32_16x16x32_bf16 v[56:59], v[80:83], v[120:123], v[56:59]
    v_mfma_f32_16x16x32_bf16 v[56:59], v[84:87], v[116:119], v[56:59]
    v_mfma_f32_16x16x32_bf16 v[56:59], v[88:91], v[112:115], v[56:59]
    ds_read_b128 v[88:91], v13 offset:1280
    ds_read_b128 v[120:123], v14 offset:2816
    v_mfma_f32_16x16x32_bf16 v[52:55], v[80:83], v[116:119], v[52:55]
    buffer_load_dwordx4 v[232:235], v4, s[36:39], s50 offen offset:2048 sc1
    v_mfma_f32_16x16x32_bf16 v[52:55], v[84:87], v[112:115], v[52:55]
    ds_read_b128 v[84:87], v13 offset:768
    ds_read_b128 v[116:119], v14 offset:3328
    v_mfma_f32_16x16x32_bf16 v[48:51], v[80:83], v[112:115], v[48:51]
    ds_read_b128 v[80:83], v13 offset:256
    ds_read_b128 v[112:115], v15
    s_waitcnt lgkmcnt(7)
    v_mfma_f32_16x16x32_bf16 v[76:79], v[92:95], v[128:131], v[76:79]
    s_waitcnt lgkmcnt(6)
    v_mfma_f32_16x16x32_bf16 v[76:79], v[96:99], v[124:127], v[76:79]
    s_waitcnt lgkmcnt(5)
    v_mfma_f32_16x16x32_bf16 v[76:79], v[88:91], v[132:135], v[76:79]
    buffer_load_dwordx4 v[236:239], v4, s[36:39], s50 offen offset:3072 sc1
    s_waitcnt lgkmcnt(4)
    v_mfma_f32_16x16x32_bf16 v[76:79], v[100:103], v[120:123], v[76:79]
    s_waitcnt lgkmcnt(3)
    v_mfma_f32_16x16x32_bf16 v[76:79], v[84:87], v[136:139], v[76:79]
    s_waitcnt lgkmcnt(2)
    v_mfma_f32_16x16x32_bf16 v[76:79], v[104:107], v[116:119], v[76:79]
    s_waitcnt lgkmcnt(1)
    v_mfma_f32_16x16x32_bf16 v[76:79], v[80:83], v[140:143], v[76:79]
    s_waitcnt lgkmcnt(0)
    v_mfma_f32_16x16x32_bf16 v[76:79], v[108:111], v[112:115], v[76:79]
    s_add_u32 s50, s13, 61440
    buffer_load_dwordx4 v[240:243], v4, s[36:39], s50 offen offset:0 sc1
    v_mfma_f32_16x16x32_bf16 v[72:75], v[80:83], v[136:139], v[72:75]
    v_mfma_f32_16x16x32_bf16 v[72:75], v[84:87], v[132:135], v[72:75]
    v_mfma_f32_16x16x32_bf16 v[72:75], v[88:91], v[128:131], v[72:75]
    v_mfma_f32_16x16x32_bf16 v[72:75], v[92:95], v[124:127], v[72:75]
    v_mfma_f32_16x16x32_bf16 v[72:75], v[96:99], v[120:123], v[72:75]
    buffer_load_dwordx4 v[244:247], v4, s[36:39], s50 offen offset:1024 sc1
    v_mfma_f32_16x16x32_bf16 v[72:75], v[100:103], v[116:119], v[72:75]
    v_mfma_f32_16x16x32_bf16 v[72:75], v[104:107], v[112:115], v[72:75]
    v_lshrrev_b32 v17, 1, v2
    v_lshlrev_b32 v17, 6, v17
    v_lshl_add_u32 v17, v3, 4, v17
    v_and_b32 v18, 1, v2
    v_lshl_add_u32 v17, v18, 3, v17
    v_mfma_f32_16x16x32_bf16 v[68:71], v[80:83], v[132:135], v[68:71]
    v_cvt_pk_bf16_f32 v76, v76, v77
    v_cvt_pk_bf16_f32 v77, v78, v79
    buffer_store_dwordx2 v[76:77], v17, s[36:39], s22 offen offset:3584 sc1
    v_mfma_f32_16x16x32_bf16 v[68:71], v[84:87], v[128:131], v[68:71]
    buffer_load_dwordx4 v[248:251], v4, s[36:39], s50 offen offset:2048 sc1
    v_mfma_f32_16x16x32_bf16 v[68:71], v[88:91], v[124:127], v[68:71]
    v_mfma_f32_16x16x32_bf16 v[68:71], v[92:95], v[120:123], v[68:71]
    v_mfma_f32_16x16x32_bf16 v[68:71], v[96:99], v[116:119], v[68:71]
    v_mfma_f32_16x16x32_bf16 v[68:71], v[100:103], v[112:115], v[68:71]
    v_mfma_f32_16x16x32_bf16 v[64:67], v[80:83], v[128:131], v[64:67]
    buffer_load_dwordx4 v[252:255], v4, s[36:39], s50 offen offset:3072 sc1
    v_cvt_pk_bf16_f32 v72, v72, v73
    v_cvt_pk_bf16_f32 v73, v74, v75
    buffer_store_dwordx2 v[72:73], v17, s[36:39], s22 offen offset:3072 sc1
    v_mfma_f32_16x16x32_bf16 v[64:67], v[84:87], v[124:127], v[64:67]
    v_mfma_f32_16x16x32_bf16 v[64:67], v[88:91], v[120:123], v[64:67]
    v_mfma_f32_16x16x32_bf16 v[64:67], v[92:95], v[116:119], v[64:67]
    v_mfma_f32_16x16x32_bf16 v[64:67], v[96:99], v[112:115], v[64:67]
    v_mfma_f32_16x16x32_bf16 v[60:63], v[80:83], v[124:127], v[60:63]
    s_add_u32 s50, s13, 65536
    buffer_load_dwordx4 a[100:103], v4, s[36:39], s50 offen offset:0 sc1
    v_cvt_pk_bf16_f32 v68, v68, v69
    v_cvt_pk_bf16_f32 v69, v70, v71
    buffer_store_dwordx2 v[68:69], v17, s[36:39], s22 offen offset:2560 sc1
    v_mfma_f32_16x16x32_bf16 v[60:63], v[84:87], v[120:123], v[60:63]
    v_mfma_f32_16x16x32_bf16 v[60:63], v[88:91], v[116:119], v[60:63]
    v_mfma_f32_16x16x32_bf16 v[60:63], v[92:95], v[112:115], v[60:63]
    v_mfma_f32_16x16x32_bf16 v[56:59], v[80:83], v[120:123], v[56:59]
    v_cvt_pk_bf16_f32 v64, v64, v65
    v_cvt_pk_bf16_f32 v65, v66, v67
    buffer_store_dwordx2 v[64:65], v17, s[36:39], s22 offen offset:2048 sc1
    v_mfma_f32_16x16x32_bf16 v[56:59], v[84:87], v[116:119], v[56:59]
    s_add_u32 s50, s14, 65536
    buffer_load_dwordx4 a[104:107], v4, s[36:39], s50 offen offset:1024 sc1
    v_mfma_f32_16x16x32_bf16 v[56:59], v[88:91], v[112:115], v[56:59]
    v_mfma_f32_16x16x32_bf16 v[52:55], v[80:83], v[116:119], v[52:55]
    v_cvt_pk_bf16_f32 v60, v60, v61
    v_cvt_pk_bf16_f32 v61, v62, v63
    buffer_store_dwordx2 v[60:61], v17, s[36:39], s22 offen offset:1536 sc1
    v_mfma_f32_16x16x32_bf16 v[52:55], v[84:87], v[112:115], v[52:55]
    v_mfma_f32_16x16x32_bf16 v[48:51], v[80:83], v[112:115], v[48:51]
    s_nop 1
    v_cvt_pk_bf16_f32 v56, v56, v57
    v_cvt_pk_bf16_f32 v57, v58, v59
    buffer_store_dwordx2 v[56:57], v17, s[36:39], s22 offen offset:1024 sc1
    s_nop 1
    v_cvt_pk_bf16_f32 v52, v52, v53
    v_cvt_pk_bf16_f32 v53, v54, v55
    buffer_store_dwordx2 v[52:53], v17, s[36:39], s22 offen offset:512 sc1
    v_cvt_pk_bf16_f32 v48, v48, v49
    v_cvt_pk_bf16_f32 v49, v50, v51
    buffer_store_dwordx2 v[48:49], v17, s[36:39], s22 offen offset:0 sc1
    s_branch L_join_31
L_alt_30:
    s_add_u32 s50, s13, 28672
    buffer_load_dwordx4 a[248:251], v4, s[36:39], s50 offen offset:1024 sc1
    s_add_u32 s50, s13, 28672
    buffer_load_dwordx4 a[252:255], v4, s[36:39], s50 offen offset:2048 sc1
    s_add_u32 s50, s13, 28672
    buffer_load_dwordx4 a[0:3], v4, s[36:39], s50 offen offset:3072 sc1
    s_add_u32 s50, s13, 32768
    buffer_load_dwordx4 a[4:7], v4, s[36:39], s50 offen offset:0 sc1
    s_add_u32 s50, s13, 32768
    buffer_load_dwordx4 a[8:11], v4, s[36:39], s50 offen offset:1024 sc1
    s_add_u32 s50, s13, 32768
    buffer_load_dwordx4 a[12:15], v4, s[36:39], s50 offen offset:2048 sc1
    s_add_u32 s50, s13, 32768
    buffer_load_dwordx4 a[16:19], v4, s[36:39], s50 offen offset:3072 sc1
    s_add_u32 s50, s13, 36864
    buffer_load_dwordx4 a[20:23], v4, s[36:39], s50 offen offset:0 sc1
    s_waitcnt vmcnt(8)
    s_barrier
    s_cmp_lg_u32 s58, 0
    s_cbranch_scc1 L_nofl_33
    v_mov_b32 v10, s64
    v_mov_b32 v11, s65
    v_mov_b32 v12, 0x2000
    s_mov_b64 exec, 1
    buffer_store_dwordx2 v[10:11], v12, s[36:39], s24 offen sc1
    s_mov_b64 exec, -1
L_nofl_33:
    s_add_u32 s50, s13, 36864
    buffer_load_dwordx4 a[24:27], v4, s[36:39], s50 offen offset:1024 sc1
    s_add_u32 s50, s13, 36864
    buffer_load_dwordx4 a[28:31], v4, s[36:39], s50 offen offset:2048 sc1
    s_add_u32 s50, s13, 36864
    buffer_load_dwordx4 a[32:35], v4, s[36:39], s50 offen offset:3072 sc1
    s_add_u32 s50, s13, 40960
    buffer_load_dwordx4 a[36:39], v4, s[36:39], s50 offen offset:0 sc1
    s_add_u32 s50, s13, 40960
    buffer_load_dwordx4 a[40:43], v4, s[36:39], s50 offen offset:1024 sc1
    s_add_u32 s50, s13, 40960
    buffer_load_dwordx4 a[44:47], v4, s[36:39], s50 offen offset:2048 sc1
    s_add_u32 s50, s13, 40960
    buffer_load_dwordx4 a[48:51], v4, s[36:39], s50 offen offset:3072 sc1
    s_add_u32 s50, s13, 45056
    buffer_load_dwordx4 a[52:55], v4, s[36:39], s50 offen offset:0 sc1
    s_add_u32 s50, s13, 45056
    buffer_load_dwordx4 a[56:59], v4, s[36:39], s50 offen offset:1024 sc1
    s_add_u32 s50, s13, 45056
    buffer_load_dwordx4 a[60:63], v4, s[36:39], s50 offen offset:2048 sc1
    s_add_u32 s50, s13, 45056
    buffer_load_dwordx4 a[64:67], v4, s[36:39], s50 offen offset:3072 sc1
    s_add_u32 s50, s13, 49152
    buffer_load_dwordx4 a[68:71], v4, s[36:39], s50 offen offset:0 sc1
    s_add_u32 s50, s13, 49152
    buffer_load_dwordx4 a[72:75], v4, s[36:39], s50 offen offset:1024 sc1
    s_add_u32 s50, s13, 49152
    buffer_load_dwordx4 a[76:79], v4, s[36:39], s50 offen offset:2048 sc1
    s_add_u32 s50, s13, 49152
    buffer_load_dwordx4 a[80:83], v4, s[36:39], s50 offen offset:3072 sc1
    s_add_u32 s50, s13, 53248
    buffer_load_dwordx4 a[84:87], v4, s[36:39], s50 offen offset:0 sc1
    s_add_u32 s50, s13, 53248
    buffer_load_dwordx4 a[88:91], v4, s[36:39], s50 offen offset:1024 sc1
    s_add_u32 s50, s13, 53248
    buffer_load_dwordx4 a[92:95], v4, s[36:39], s50 offen offset:2048 sc1
    s_add_u32 s50, s13, 53248
    buffer_load_dwordx4 a[96:99], v4, s[36:39], s50 offen offset:3072 sc1
    s_add_u32 s50, s13, 57344
    buffer_load_dwordx4 v[224:227], v4, s[36:39], s50 offen offset:0 sc1
    s_add_u32 s50, s13, 57344
    buffer_load_dwordx4 v[228:231], v4, s[36:39], s50 offen offset:1024 sc1
    s_add_u32 s50, s13, 57344
    buffer_load_dwordx4 v[232:235], v4, s[36:39], s50 offen offset:2048 sc1
    s_add_u32 s50, s13, 57344
    buffer_load_dwordx4 v[236:239], v4, s[36:39], s50 offen offset:3072 sc1
    s_add_u32 s50, s13, 61440
    buffer_load_dwordx4 v[240:243], v4, s[36:39], s50 offen offset:0 sc1
    s_add_u32 s50, s13, 61440
    buffer_load_dwordx4 v[244:247], v4, s[36:39], s50 offen offset:1024 sc1
    s_add_u32 s50, s13, 61440
    buffer_load_dwordx4 v[248:251], v4, s[36:39], s50 offen offset:2048 sc1
    s_add_u32 s50, s13, 61440
    buffer_load_dwordx4 v[252:255], v4, s[36:39], s50 offen offset:3072 sc1
    s_add_u32 s50, s13, 65536
    buffer_load_dwordx4 a[100:103], v4, s[36:39], s50 offen offset:0 sc1
    s_add_u32 s50, s14, 65536
    buffer_load_dwordx4 a[104:107], v4, s[36:39], s50 offen offset:1024 sc1
    s_cmp_lg_u32 s58, 3
    s_cbranch_scc1 L_nw3_34
    s_lshl_b32 s44, s56, 7
    s_add_u32 s44, s44, 0x1d02000
    v_lshlrev_b32 v9, 3, v1
    s_mov_b32 s100, 0
    s_mov_b64 exec, 0xff
L_poll_35:
    buffer_load_dwordx2 v[10:11], v9, s[36:39], s44 offen sc1
    s_add_u32 s100, s100, 1
    s_cmp_gt_u32 s100, 200000
    s_waitcnt vmcnt(0)
    s_cbranch_scc1 L_pdone_36
    v_cmp_ne_u64 vcc, s[64:65], v[10:11]
    s_cbranch_vccnz L_poll_35
L_pdone_36:
    s_mov_b64 exec, -1
L_nw3_34:
L_join_31:
    s_barrier
    buffer_load_dwordx4 v[80:83], v46, s[36:39], s15 offen sc1
    s_add_u32 s101, s15, 131072
    buffer_load_dwordx4 v[84:87], v46, s[36:39], s101 offen sc1
    s_add_u32 s101, s15, 262144
    buffer_load_dwordx4 v[88:91], v46, s[36:39], s101 offen sc1
    s_add_u32 s101, s15, 393216
    buffer_load_dwordx4 v[92:95], v46, s[36:39], s101 offen sc1
    s_add_u32 s101, s15, 524288
    buffer_load_dwordx4 v[96:99], v46, s[36:39], s101 offen sc1
    s_add_u32 s101, s15, 655360
    buffer_load_dwordx4 v[100:103], v46, s[36:39], s101 offen sc1
    s_add_u32 s101, s15, 786432
    buffer_load_dwordx4 v[104:107], v46, s[36:39], s101 offen sc1
    s_add_u32 s101, s15, 917504
    buffer_load_dwordx4 v[108:111], v46, s[36:39], s101 offen sc1
    s_add_u32 s101, s15, 1048576
    buffer_load_dwordx4 v[112:115], v46, s[36:39], s101 offen sc1
    s_add_u32 s101, s15, 1179648
    buffer_load_dwordx4 v[116:119], v46, s[36:39], s101 offen sc1
    s_add_u32 s101, s15, 1310720
    buffer_load_dwordx4 v[120:123], v46, s[36:39], s101 offen sc1
    s_waitcnt vmcnt(10)
    v_mfma_f32_16x16x32_bf16 v[160:163], a[132:135], v[80:83], 0
    v_min_u32 v13, 19, v1
    s_mul_i32 s70, s58, 20
    v_mfma_f32_16x16x32_bf16 v[164:167], a[136:139], v[80:83], 0
    v_add_u32 v13, s70, v13
    v_lshrrev_b32 v14, 3, v13
    v_mfma_f32_16x16x32_bf16 v[168:171], a[140:143], v[80:83], 0
    v_and_b32 v13, 7, v13
    v_lshlrev_b32 v13, 3, v13
    v_mfma_f32_16x16x32_bf16 v[172:175], a[144:147], v[80:83], 0
    v_lshl_add_u32 v13, v14, 7, v13
    s_mul_i32 s71, s57, 80
    v_mfma_f32_16x16x32_bf16 v[176:179], a[148:151], v[80:83], 0
    s_add_u32 s70, s70, s71
    s_lshl_b32 s70, s70, 12
    s_add_u32 s101, s15, 1441792
    buffer_load_dwordx4 v[124:127], v46, s[36:39], s101 offen sc1
    s_cmp_lg_u32 s60, 1
    s_cbranch_scc1 L_nofl_37
    v_mov_b32 v10, s64
    v_mov_b32 v11, s65
    v_mov_b32 v12, 0x0
    s_mov_b64 exec, 1
    buffer_store_dwordx2 v[10:11], v12, s[36:39], s27 offen sc1
    s_mov_b64 exec, -1
L_nofl_37:
    s_waitcnt vmcnt(10)
    v_mfma_f32_16x16x32_bf16 v[160:163], a[152:155], v[84:87], v[160:163]
    s_lshl_b32 s71, s56, 7
    s_add_u32 s70, s70, s71
    v_mfma_f32_16x16x32_bf16 v[164:167], a[156:159], v[84:87], v[164:167]
    s_add_u32 s72, s70, 0x1900000
    v_lshrrev_b32 v14, 3, v1
    v_mfma_f32_16x16x32_bf16 v[168:171], a[160:163], v[84:87], v[168:171]
    v_lshlrev_b32 v14, 12, v14
    v_and_b32 v15, 7, v1
    v_mfma_f32_16x16x32_bf16 v[172:175], a[164:167], v[84:87], v[172:175]
    v_lshl_add_u32 v14, v15, 4, v14
    v_and_b32 v15, 8, v2
    v_mfma_f32_16x16x32_bf16 v[176:179], a[168:171], v[84:87], v[176:179]
    v_and_b32 v16, 1, v2
    v_lshl_add_u32 v15, v16, 2, v15
    s_add_u32 s101, s15, 1572864
    buffer_load_dwordx4 v[128:131], v46, s[36:39], s101 offen sc1
    s_waitcnt vmcnt(10)
    v_mfma_f32_16x16x32_bf16 v[160:163], a[172:175], v[88:91], v[160:163]
    v_bfe_u32 v16, v2, 1, 2
    s_lshl_b32 s70, s69, 4
    v_mfma_f32_16x16x32_bf16 v[164:167], a[176:179], v[88:91], v[164:167]
    s_add_u32 s70, s70, 30720
    v_add3_u32 v15, v15, v16, s70
    v_mfma_f32_16x16x32_bf16 v[168:171], a[180:183], v[88:91], v[168:171]
    v_lshlrev_b32 v15, 1, v15
    v_lshl_add_u32 v16, v3, 9, v15
    v_mfma_f32_16x16x32_bf16 v[172:175], a[184:187], v[88:91], v[172:175]
    v_lshl_add_u32 v15, v3, 10, v15
    s_mul_i32 s73, s58, 2560
    v_mfma_f32_16x16x32_bf16 v[176:179], a[188:191], v[88:91], v[176:179]
    s_add_u32 s73, s73, 61440
    v_lshlrev_b32 v200, 16, v34
    s_add_u32 s101, s15, s19
    buffer_load_dwordx4 v[132:135], v46, s[36:39], s101 offen sc1
    s_waitcnt vmcnt(10)
    v_mfma_f32_16x16x32_bf16 v[160:163], a[192:195], v[92:95], v[160:163]
    v_and_b32 v201, s63, v34
    v_lshlrev_b32 v202, 16, v35
    v_mfma_f32_16x16x32_bf16 v[164:167], a[196:199], v[92:95], v[164:167]
    v_and_b32 v203, s63, v35
    v_lshlrev_b32 v204, 16, v36
    v_mfma_f32_16x16x32_bf16 v[168:171], a[200:203], v[92:95], v[168:171]
    v_and_b32 v205, s63, v36
    v_lshlrev_b32 v206, 16, v37
    v_mfma_f32_16x16x32_bf16 v[172:175], a[204:207], v[92:95], v[172:175]
    v_and_b32 v207, s63, v37
    v_lshlrev_b32 v208, 16, v38
    v_mfma_f32_16x16x32_bf16 v[176:179], a[208:211], v[92:95], v[176:179]
    v_and_b32 v209, s63, v38
    v_lshlrev_b32 v210, 16, v39
    buffer_load_dwordx4 v[136:139], v46, s[36:39], s16 offen sc1
    s_waitcnt vmcnt(10)
    v_mfma_f32_16x16x32_bf16 v[160:163], a[212:215], v[96:99], v[160:163]
    v_and_b32 v211, s63, v39
    v_lshlrev_b32 v212, 16, v40
    v_mfma_f32_16x16x32_bf16 v[164:167], a[216:219], v[96:99], v[164:167]
    v_and_b32 v213, s63, v40
    v_lshlrev_b32 v214, 16, v41
    v_mfma_f32_16x16x32_bf16 v[168:171], a[220:223], v[96:99], v[168:171]
    v_and_b32 v215, s63, v41
    v_lshlrev_b32 v216, 16, v42
    v_mfma_f32_16x16x32_bf16 v[172:175], a[224:227], v[96:99], v[172:175]
    v_and_b32 v217, s63, v42
    v_lshlrev_b32 v218, 16, v43
    v_mfma_f32_16x16x32_bf16 v[176:179], a[228:231], v[96:99], v[176:179]
    v_and_b32 v219, s63, v43
    v_mov_b32 v68, 0
    s_add_u32 s101, s16, 131072
    buffer_load_dwordx4 v[140:143], v46, s[36:39], s101 offen sc1
    s_waitcnt vmcnt(10)
    v_mfma_f32_16x16x32_bf16 v[160:163], a[232:235], v[100:103], v[160:163]
    v_mov_b32 v69, 0
    v_mov_b32 v70, 0
    v_mfma_f32_16x16x32_bf16 v[164:167], a[236:239], v[100:103], v[164:167]
    v_mov_b32 v71, 0
    v_mov_b32 v72, 0
    v_mfma_f32_16x16x32_bf16 v[168:171], a[240:243], v[100:103], v[168:171]
    v_mov_b32 v73, 0
    v_mov_b32 v74, 0
    v_mfma_f32_16x16x32_bf16 v[172:175], a[244:247], v[100:103], v[172:175]
    v_mov_b32 v75, 0
    v_mov_b32 v76, 0
    v_mfma_f32_16x16x32_bf16 v[176:179], a[248:251], v[100:103], v[176:179]
    v_mov_b32 v77, 0
    v_mov_b32 v78, 0
    s_add_u32 s101, s16, 262144
    buffer_load_dwordx4 v[144:147], v46, s[36:39], s101 offen sc1
    s_waitcnt vmcnt(10)
    v_mfma_f32_16x16x32_bf16 v[160:163], a[252:255], v[104:107], v[160:163]
    v_mov_b32 v79, 0
    v_mov_b32 v34, 0
    v_mfma_f32_16x16x32_bf16 v[164:167], a[0:3], v[104:107], v[164:167]
    v_mov_b32 v35, 0
    v_mov_b32 v36, 0
    v_mfma_f32_16x16x32_bf16 v[168:171], a[4:7], v[104:107], v[168:171]
    v_mov_b32 v37, 0
    v_mov_b32 v38, 0
    v_mfma_f32_16x16x32_bf16 v[172:175], a[8:11], v[104:107], v[172:175]
    v_mov_b32 v39, 0
    v_mov_b32 v40, 0
    v_mfma_f32_16x16x32_bf16 v[176:179], a[12:15], v[104:107], v[176:179]
    v_mov_b32 v41, 0
    v_mul_u32_u24 v20, 1280, v2
    s_add_u32 s101, s16, 393216
    buffer_load_dwordx4 v[148:151], v46, s[36:39], s101 offen sc1
    s_waitcnt vmcnt(10)
    v_mfma_f32_16x16x32_bf16 v[160:163], a[16:19], v[108:111], v[160:163]
    v_lshl_add_u32 v21, v3, 3, v20
    v_lshl_add_u32 v20, v3, 4, v20
    v_mfma_f32_16x16x32_bf16 v[164:167], a[20:23], v[108:111], v[164:167]
    s_mov_b32 s94, 0xbfb8aa3b
    v_mul_u32_u24 v20, 160, v2
    v_mfma_f32_16x16x32_bf16 v[168:171], a[24:27], v[108:111], v[168:171]
    v_add_u32 v20, s92, v20
    v_lshl_add_u32 v21, v3, 3, v20
    v_mfma_f32_16x16x32_bf16 v[172:175], a[28:31], v[108:111], v[172:175]
    v_lshl_add_u32 v20, v3, 4, v20
    s_nop 0
    v_mfma_f32_16x16x32_bf16 v[176:179], a[32:35], v[108:111], v[176:179]
    s_add_u32 s101, s16, 524288
    buffer_load_dwordx4 v[152:155], v46, s[36:39], s101 offen sc1
    s_waitcnt vmcnt(10)
    v_mfma_f32_16x16x32_bf16 v[160:163], a[36:39], v[112:115], v[160:163]
    v_mfma_f32_16x16x32_bf16 v[164:167], a[40:43], v[112:115], v[164:167]
    v_mfma_f32_16x16x32_bf16 v[168:171], a[44:47], v[112:115], v[168:171]
    v_mfma_f32_16x16x32_bf16 v[172:175], a[48:51], v[112:115], v[172:175]
    v_mfma_f32_16x16x32_bf16 v[176:179], a[52:55], v[112:115], v[176:179]
    s_add_u32 s101, s16, 655360
    buffer_load_dwordx4 v[156:159], v46, s[36:39], s101 offen sc1
    s_waitcnt vmcnt(10)
    v_mfma_f32_16x16x32_bf16 v[160:163], a[56:59], v[116:119], v[160:163]
    v_mfma_f32_16x16x32_bf16 v[164:167], a[60:63], v[116:119], v[164:167]
    v_mfma_f32_16x16x32_bf16 v[168:171], a[64:67], v[116:119], v[168:171]
    v_mfma_f32_16x16x32_bf16 v[172:175], a[68:71], v[116:119], v[172:175]
    v_mfma_f32_16x16x32_bf16 v[176:179], a[72:75], v[116:119], v[176:179]
    s_add_u32 s101, s16, 786432
    buffer_load_dwordx4 v[80:83], v46, s[36:39], s101 offen sc1
    s_waitcnt vmcnt(10)
    v_mfma_f32_16x16x32_bf16 v[160:163], a[76:79], v[120:123], v[160:163]
    v_mfma_f32_16x16x32_bf16 v[164:167], a[80:83], v[120:123], v[164:167]
    v_mfma_f32_16x16x32_bf16 v[168:171], a[84:87], v[120:123], v[168:171]
    v_mfma_f32_16x16x32_bf16 v[172:175], a[88:91], v[120:123], v[172:175]
    v_mfma_f32_16x16x32_bf16 v[176:179], a[92:95], v[120:123], v[176:179]
    buffer_load_dwordx4 a[108:111], v4, s[36:39], s50 offen offset:2048 sc1
    buffer_load_dwordx4 a[112:115], v4, s[36:39], s50 offen offset:3072 sc1
    s_add_u32 s50, s14, 69632
    buffer_load_dwordx4 a[116:119], v4, s[36:39], s50 offen offset:0 sc1
    buffer_load_dwordx4 a[120:123], v4, s[36:39], s50 offen offset:1024 sc1
    s_add_u32 s101, s16, 917504
    buffer_load_dwordx4 v[84:87], v46, s[36:39], s101 offen sc1
    s_waitcnt vmcnt(14)
    v_mfma_f32_16x16x32_bf16 v[160:163], a[96:99], v[124:127], v[160:163]
    v_mfma_f32_16x16x32_bf16 v[164:167], v[224:227], v[124:127], v[164:167]
    v_mfma_f32_16x16x32_bf16 v[168:171], v[228:231], v[124:127], v[168:171]
    v_mfma_f32_16x16x32_bf16 v[172:175], v[232:235], v[124:127], v[172:175]
    v_mfma_f32_16x16x32_bf16 v[176:179], v[236:239], v[124:127], v[176:179]
    s_add_u32 s101, s16, 1048576
    buffer_load_dwordx4 v[88:91], v46, s[36:39], s101 offen sc1
    s_waitcnt vmcnt(14)
    v_mfma_f32_16x16x32_bf16 v[160:163], v[240:243], v[128:131], v[160:163]
    v_mfma_f32_16x16x32_bf16 v[164:167], v[244:247], v[128:131], v[164:167]
    v_mfma_f32_16x16x32_bf16 v[168:171], v[248:251], v[128:131], v[168:171]
    v_mfma_f32_16x16x32_bf16 v[172:175], v[252:255], v[128:131], v[172:175]
    v_mfma_f32_16x16x32_bf16 v[176:179], a[100:103], v[128:131], v[176:179]
    s_add_u32 s101, s16, 1179648
    buffer_load_dwordx4 v[92:95], v46, s[36:39], s101 offen sc1
    s_waitcnt vmcnt(3)
    v_mfma_f32_16x16x32_bf16 v[160:163], a[104:107], v[132:135], v[160:163]
    v_mfma_f32_16x16x32_bf16 v[164:167], a[108:111], v[132:135], v[164:167]
    v_mfma_f32_16x16x32_bf16 v[168:171], a[112:115], v[132:135], v[168:171]
    v_mfma_f32_16x16x32_bf16 v[172:175], a[116:119], v[132:135], v[172:175]
    v_mfma_f32_16x16x32_bf16 v[176:179], a[120:123], v[132:135], v[176:179]
    s_add_u32 s101, s16, 1310720
    buffer_load_dwordx4 v[96:99], v46, s[36:39], s101 offen sc1
    v_mfma_f32_16x16x32_bf16 v[180:183], a[132:135], v[136:139], 0
    v_mfma_f32_16x16x32_bf16 v[184:187], a[136:139], v[136:139], 0
    v_mfma_f32_16x16x32_bf16 v[188:191], a[140:143], v[136:139], 0
    v_mfma_f32_16x16x32_bf16 v[192:195], a[144:147], v[136:139], 0
    v_mfma_f32_16x16x32_bf16 v[196:199], a[148:151], v[136:139], 0
    ds_write_b128 v5, v[160:163] offset:0
    s_add_u32 s101, s16, 1441792
    buffer_load_dwordx4 v[100:103], v46, s[36:39], s101 offen sc1
    v_mfma_f32_16x16x32_bf16 v[180:183], a[152:155], v[140:143], v[180:183]
    ds_write_b128 v5, v[164:167] offset:1024
    v_mfma_f32_16x16x32_bf16 v[184:187], a[156:159], v[140:143], v[184:187]
    ds_write_b128 v5, v[168:171] offset:2048
    v_mfma_f32_16x16x32_bf16 v[188:191], a[160:163], v[140:143], v[188:191]
    ds_write_b128 v5, v[172:175] offset:3072
    v_mfma_f32_16x16x32_bf16 v[192:195], a[164:167], v[140:143], v[192:195]
    ds_write_b128 v5, v[176:179] offset:4096
    v_mfma_f32_16x16x32_bf16 v[196:199], a[168:171], v[140:143], v[196:199]
    s_add_u32 s101, s16, 1572864
    buffer_load_dwordx4 v[104:107], v46, s[36:39], s101 offen sc1
    v_mfma_f32_16x16x32_bf16 v[180:183], a[172:175], v[144:147], v[180:183]
    v_mfma_f32_16x16x32_bf16 v[184:187], a[176:179], v[144:147], v[184:187]
    v_mfma_f32_16x16x32_bf16 v[188:191], a[180:183], v[144:147], v[188:191]
    v_mfma_f32_16x16x32_bf16 v[192:195], a[184:187], v[144:147], v[192:195]
    v_mfma_f32_16x16x32_bf16 v[196:199], a[188:191], v[144:147], v[196:199]
    s_add_u32 s101, s16, s19
    buffer_load_dwordx4 v[108:111], v46, s[36:39], s101 offen sc1
    v_mfma_f32_16x16x32_bf16 v[180:183], a[192:195], v[148:151], v[180:183]
    v_mfma_f32_16x16x32_bf16 v[184:187], a[196:199], v[148:151], v[184:187]
    v_mfma_f32_16x16x32_bf16 v[188:191], a[200:203], v[148:151], v[188:191]
    v_mfma_f32_16x16x32_bf16 v[192:195], a[204:207], v[148:151], v[192:195]
    v_mfma_f32_16x16x32_bf16 v[196:199], a[208:211], v[148:151], v[196:199]
    buffer_load_dwordx4 v[112:115], v46, s[36:39], s17 offen sc1
    v_mfma_f32_16x16x32_bf16 v[180:183], a[212:215], v[152:155], v[180:183]
    v_mfma_f32_16x16x32_bf16 v[184:187], a[216:219], v[152:155], v[184:187]
    v_mfma_f32_16x16x32_bf16 v[188:191], a[220:223], v[152:155], v[188:191]
    v_mfma_f32_16x16x32_bf16 v[192:195], a[224:227], v[152:155], v[192:195]
    v_mfma_f32_16x16x32_bf16 v[196:199], a[228:231], v[152:155], v[196:199]
    s_add_u32 s101, s17, 131072
    buffer_load_dwordx4 v[116:119], v46, s[36:39], s101 offen sc1
    v_mfma_f32_16x16x32_bf16 v[180:183], a[232:235], v[156:159], v[180:183]
    v_mfma_f32_16x16x32_bf16 v[184:187], a[236:239], v[156:159], v[184:187]
    v_mfma_f32_16x16x32_bf16 v[188:191], a[240:243], v[156:159], v[188:191]
    v_mfma_f32_16x16x32_bf16 v[192:195], a[244:247], v[156:159], v[192:195]
    v_mfma_f32_16x16x32_bf16 v[196:199], a[248:251], v[156:159], v[196:199]
    s_add_u32 s101, s17, 262144
    buffer_load_dwordx4 v[120:123], v46, s[36:39], s101 offen sc1
    v_mfma_f32_16x16x32_bf16 v[180:183], a[252:255], v[80:83], v[180:183]
    v_mfma_f32_16x16x32_bf16 v[184:187], a[0:3], v[80:83], v[184:187]
    v_mfma_f32_16x16x32_bf16 v[188:191], a[4:7], v[80:83], v[188:191]
    v_mfma_f32_16x16x32_bf16 v[192:195], a[8:11], v[80:83], v[192:195]
    v_mfma_f32_16x16x32_bf16 v[196:199], a[12:15], v[80:83], v[196:199]
    s_add_u32 s101, s17, 393216
    buffer_load_dwordx4 v[124:127], v46, s[36:39], s101 offen sc1
    s_waitcnt vmcnt(10)
    v_mfma_f32_16x16x32_bf16 v[180:183], a[16:19], v[84:87], v[180:183]
    v_mfma_f32_16x16x32_bf16 v[184:187], a[20:23], v[84:87], v[184:187]
    v_mfma_f32_16x16x32_bf16 v[188:191], a[24:27], v[84:87], v[188:191]
    v_mfma_f32_16x16x32_bf16 v[192:195], a[28:31], v[84:87], v[192:195]
    v_mfma_f32_16x16x32_bf16 v[196:199], a[32:35], v[84:87], v[196:199]
    s_add_u32 s101, s17, 524288
    buffer_load_dwordx4 v[128:131], v46, s[36:39], s101 offen sc1
    s_waitcnt vmcnt(10)
    v_mfma_f32_16x16x32_bf16 v[180:183], a[36:39], v[88:91], v[180:183]
    v_mfma_f32_16x16x32_bf16 v[184:187], a[40:43], v[88:91], v[184:187]
    v_mfma_f32_16x16x32_bf16 v[188:191], a[44:47], v[88:91], v[188:191]
    v_mfma_f32_16x16x32_bf16 v[192:195], a[48:51], v[88:91], v[192:195]
    v_mfma_f32_16x16x32_bf16 v[196:199], a[52:55], v[88:91], v[196:199]
    s_add_u32 s101, s17, 655360
    buffer_load_dwordx4 v[132:135], v46, s[36:39], s101 offen sc1
    s_waitcnt vmcnt(10)
    v_mfma_f32_16x16x32_bf16 v[180:183], a[56:59], v[92:95], v[180:183]
    v_mfma_f32_16x16x32_bf16 v[184:187], a[60:63], v[92:95], v[184:187]
    v_mfma_f32_16x16x32_bf16 v[188:191], a[64:67], v[92:95], v[188:191]
    v_mfma_f32_16x16x32_bf16 v[192:195], a[68:71], v[92:95], v[192:195]
    v_mfma_f32_16x16x32_bf16 v[196:199], a[72:75], v[92:95], v[196:199]
    s_add_u32 s101, s17, 786432
    buffer_load_dwordx4 v[136:139], v46, s[36:39], s101 offen sc1
    s_waitcnt vmcnt(10)
    v_mfma_f32_16x16x32_bf16 v[180:183], a[76:79], v[96:99], v[180:183]
    v_mfma_f32_16x16x32_bf16 v[184:187], a[80:83], v[96:99], v[184:187]
    v_mfma_f32_16x16x32_bf16 v[188:191], a[84:87], v[96:99], v[188:191]
    v_mfma_f32_16x16x32_bf16 v[192:195], a[88:91], v[96:99], v[192:195]
    v_mfma_f32_16x16x32_bf16 v[196:199], a[92:95], v[96:99], v[196:199]
    s_add_u32 s101, s17, 917504
    buffer_load_dwordx4 v[140:143], v46, s[36:39], s101 offen sc1
    buffer_load_dwordx2 v[18:19], v13, s[36:39], s26 offen sc1
    s_waitcnt vmcnt(11)
    v_mfma_f32_16x16x32_bf16 v[180:183], a[96:99], v[100:103], v[180:183]
    v_mfma_f32_16x16x32_bf16 v[184:187], v[224:227], v[100:103], v[184:187]
    v_mfma_f32_16x16x32_bf16 v[188:191], v[228:231], v[100:103], v[188:191]
    v_mfma_f32_16x16x32_bf16 v[192:195], v[232:235], v[100:103], v[192:195]
    v_mfma_f32_16x16x32_bf16 v[196:199], v[236:239], v[100:103], v[196:199]
    s_add_u32 s101, s17, 1048576
    buffer_load_dwordx4 v[144:147], v46, s[36:39], s101 offen sc1
    s_waitcnt vmcnt(11)
    v_mfma_f32_16x16x32_bf16 v[180:183], v[240:243], v[104:107], v[180:183]
    v_mfma_f32_16x16x32_bf16 v[184:187], v[244:247], v[104:107], v[184:187]
    v_mfma_f32_16x16x32_bf16 v[188:191], v[248:251], v[104:107], v[188:191]
    v_mfma_f32_16x16x32_bf16 v[192:195], v[252:255], v[104:107], v[192:195]
    v_mfma_f32_16x16x32_bf16 v[196:199], a[100:103], v[104:107], v[196:199]
    s_add_u32 s101, s17, 1179648
    buffer_load_dwordx4 v[148:151], v46, s[36:39], s101 offen sc1
    s_waitcnt vmcnt(11)
    v_mfma_f32_16x16x32_bf16 v[180:183], a[104:107], v[108:111], v[180:183]
    v_mfma_f32_16x16x32_bf16 v[184:187], a[108:111], v[108:111], v[184:187]
    v_mfma_f32_16x16x32_bf16 v[188:191], a[112:115], v[108:111], v[188:191]
    v_mfma_f32_16x16x32_bf16 v[192:195], a[116:119], v[108:111], v[192:195]
    v_mfma_f32_16x16x32_bf16 v[196:199], a[120:123], v[108:111], v[196:199]
    s_add_u32 s101, s17, 1310720
    buffer_load_dwordx4 v[152:155], v46, s[36:39], s101 offen sc1
    s_waitcnt vmcnt(11)
    v_mfma_f32_16x16x32_bf16 v[160:163], a[132:135], v[112:115], 0
    v_mfma_f32_16x16x32_bf16 v[164:167], a[136:139], v[112:115], 0
    v_mfma_f32_16x16x32_bf16 v[168:171], a[140:143], v[112:115], 0
    v_mfma_f32_16x16x32_bf16 v[172:175], a[144:147], v[112:115], 0
    v_mfma_f32_16x16x32_bf16 v[176:179], a[148:151], v[112:115], 0
    ds_write_b128 v5, v[180:183] offset:5120
    s_add_u32 s101, s17, 1441792
    buffer_load_dwordx4 v[156:159], v46, s[36:39], s101 offen sc1
    s_waitcnt vmcnt(11)
    v_mfma_f32_16x16x32_bf16 v[160:163], a[152:155], v[116:119], v[160:163]
    ds_write_b128 v5, v[184:187] offset:6144
    v_mfma_f32_16x16x32_bf16 v[164:167], a[156:159], v[116:119], v[164:167]
    ds_write_b128 v5, v[188:191] offset:7168
    v_mfma_f32_16x16x32_bf16 v[168:171], a[160:163], v[116:119], v[168:171]
    ds_write_b128 v5, v[192:195] offset:8192
    v_mfma_f32_16x16x32_bf16 v[172:175], a[164:167], v[116:119], v[172:175]
    ds_write_b128 v5, v[196:199] offset:9216
    v_mfma_f32_16x16x32_bf16 v[176:179], a[168:171], v[116:119], v[176:179]
    s_add_u32 s101, s17, 1572864
    buffer_load_dwordx4 v[80:83], v46, s[36:39], s101 offen sc1
    s_waitcnt vmcnt(11)
    v_mfma_f32_16x16x32_bf16 v[160:163], a[172:175], v[120:123], v[160:163]
    v_mfma_f32_16x16x32_bf16 v[164:167], a[176:179], v[120:123], v[164:167]
    v_mfma_f32_16x16x32_bf16 v[168:171], a[180:183], v[120:123], v[168:171]
    v_mfma_f32_16x16x32_bf16 v[172:175], a[184:187], v[120:123], v[172:175]
    v_mfma_f32_16x16x32_bf16 v[176:179], a[188:191], v[120:123], v[176:179]
    s_add_u32 s101, s17, s19
    buffer_load_dwordx4 v[84:87], v46, s[36:39], s101 offen sc1
    s_waitcnt vmcnt(11)
    v_mfma_f32_16x16x32_bf16 v[160:163], a[192:195], v[124:127], v[160:163]
    v_mfma_f32_16x16x32_bf16 v[164:167], a[196:199], v[124:127], v[164:167]
    v_mfma_f32_16x16x32_bf16 v[168:171], a[200:203], v[124:127], v[168:171]
    v_mfma_f32_16x16x32_bf16 v[172:175], a[204:207], v[124:127], v[172:175]
    v_mfma_f32_16x16x32_bf16 v[176:179], a[208:211], v[124:127], v[176:179]
    buffer_load_dwordx4 v[88:91], v46, s[36:39], s18 offen sc1
    s_waitcnt vmcnt(11)
    v_mfma_f32_16x16x32_bf16 v[160:163], a[212:215], v[128:131], v[160:163]
    v_mfma_f32_16x16x32_bf16 v[164:167], a[216:219], v[128:131], v[164:167]
    v_mfma_f32_16x16x32_bf16 v[168:171], a[220:223], v[128:131], v[168:171]
    v_mfma_f32_16x16x32_bf16 v[172:175], a[224:227], v[128:131], v[172:175]
    v_mfma_f32_16x16x32_bf16 v[176:179], a[228:231], v[128:131], v[176:179]
    s_add_u32 s101, s18, 131072
    buffer_load_dwordx4 v[92:95], v46, s[36:39], s101 offen sc1
    s_waitcnt vmcnt(11)
    v_mfma_f32_16x16x32_bf16 v[160:163], a[232:235], v[132:135], v[160:163]
    v_mfma_f32_16x16x32_bf16 v[164:167], a[236:239], v[132:135], v[164:167]
    v_mfma_f32_16x16x32_bf16 v[168:171], a[240:243], v[132:135], v[168:171]
    v_mfma_f32_16x16x32_bf16 v[172:175], a[244:247], v[132:135], v[172:175]
    v_mfma_f32_16x16x32_bf16 v[176:179], a[248:251], v[132:135], v[176:179]
    s_add_u32 s101, s18, 262144
    buffer_load_dwordx4 v[96:99], v46, s[36:39], s101 offen sc1
    s_waitcnt vmcnt(11)
    v_mfma_f32_16x16x32_bf16 v[160:163], a[252:255], v[136:139], v[160:163]
    v_mfma_f32_16x16x32_bf16 v[164:167], a[0:3], v[136:139], v[164:167]
    v_mfma_f32_16x16x32_bf16 v[168:171], a[4:7], v[136:139], v[168:171]
    v_mfma_f32_16x16x32_bf16 v[172:175], a[8:11], v[136:139], v[172:175]
    v_mfma_f32_16x16x32_bf16 v[176:179], a[12:15], v[136:139], v[176:179]
    s_add_u32 s101, s18, 393216
    buffer_load_dwordx4 v[100:103], v46, s[36:39], s101 offen sc1
    s_waitcnt vmcnt(10)
    v_cmp_ne_u64 vcc, s[64:65], v[18:19]
    s_cbranch_vccz L_pok_38
    s_mov_b32 s100, 0
L_poll_39:
    buffer_load_dwordx2 v[18:19], v13, s[36:39], s26 offen sc1
    s_add_u32 s100, s100, 1
    s_cmp_gt_u32 s100, 200000
    s_waitcnt vmcnt(0)
    s_cbranch_scc1 L_pdone_40
    v_cmp_ne_u64 vcc, s[64:65], v[18:19]
    s_cbranch_vccnz L_poll_39
L_pdone_40:
L_pok_38:
    s_add_u32 m0, s73, 0
    s_nop 0
    buffer_load_dwordx4 v14, s[36:39], s72 offen sc1 lds
    s_add_u32 m0, s73, 1024
    s_add_u32 s72, s72, 32768
    buffer_load_dwordx4 v14, s[36:39], s72 offen sc1 lds
    s_add_u32 m0, s73, 2048
    s_add_u32 s72, s72, 32768
    s_mov_b32 exec_hi, 0
    buffer_load_dwordx4 v14, s[36:39], s72 offen sc1 lds
    s_mov_b64 exec, -1
    v_mfma_f32_16x16x32_bf16 v[160:163], a[16:19], v[140:143], v[160:163]
    v_mfma_f32_16x16x32_bf16 v[164:167], a[20:23], v[140:143], v[164:167]
    v_mfma_f32_16x16x32_bf16 v[168:171], a[24:27], v[140:143], v[168:171]
    v_mfma_f32_16x16x32_bf16 v[172:175], a[28:31], v[140:143], v[172:175]
    v_mfma_f32_16x16x32_bf16 v[176:179], a[32:35], v[140:143], v[176:179]
    s_add_u32 s101, s18, 524288
    buffer_load_dwordx4 v[104:107], v46, s[36:39], s101 offen sc1
    s_waitcnt vmcnt(13)
    v_mfma_f32_16x16x32_bf16 v[160:163], a[36:39], v[144:147], v[160:163]
    v_mfma_f32_16x16x32_bf16 v[164:167], a[40:43], v[144:147], v[164:167]
    v_mfma_f32_16x16x32_bf16 v[168:171], a[44:47], v[144:147], v[168:171]
    v_mfma_f32_16x16x32_bf16 v[172:175], a[48:51], v[144:147], v[172:175]
    v_mfma_f32_16x16x32_bf16 v[176:179], a[52:55], v[144:147], v[176:179]
    s_add_u32 s101, s18, 655360
    buffer_load_dwordx4 v[108:111], v46, s[36:39], s101 offen sc1
    s_waitcnt vmcnt(13)
    v_mfma_f32_16x16x32_bf16 v[160:163], a[56:59], v[148:151], v[160:163]
    v_mfma_f32_16x16x32_bf16 v[164:167], a[60:63], v[148:151], v[164:167]
    v_mfma_f32_16x16x32_bf16 v[168:171], a[64:67], v[148:151], v[168:171]
    v_mfma_f32_16x16x32_bf16 v[172:175], a[68:71], v[148:151], v[172:175]
    v_mfma_f32_16x16x32_bf16 v[176:179], a[72:75], v[148:151], v[176:179]
    s_add_u32 s101, s18, 786432
    buffer_load_dwordx4 v[112:115], v46, s[36:39], s101 offen sc1
    s_waitcnt vmcnt(13)
    v_mfma_f32_16x16x32_bf16 v[160:163], a[76:79], v[152:155], v[160:163]
    v_mfma_f32_16x16x32_bf16 v[164:167], a[80:83], v[152:155], v[164:167]
    v_mfma_f32_16x16x32_bf16 v[168:171], a[84:87], v[152:155], v[168:171]
    v_mfma_f32_16x16x32_bf16 v[172:175], a[88:91], v[152:155], v[172:175]
    v_mfma_f32_16x16x32_bf16 v[176:179], a[92:95], v[152:155], v[176:179]
    s_add_u32 s101, s18, 917504
    buffer_load_dwordx4 v[116:119], v46, s[36:39], s101 offen sc1
    s_waitcnt vmcnt(13)
    v_mfma_f32_16x16x32_bf16 v[160:163], a[96:99], v[156:159], v[160:163]
    v_mfma_f32_16x16x32_bf16 v[164:167], v[224:227], v[156:159], v[164:167]
    v_mfma_f32_16x16x32_bf16 v[168:171], v[228:231], v[156:159], v[168:171]
    v_mfma_f32_16x16x32_bf16 v[172:175], v[232:235], v[156:159], v[172:175]
    v_mfma_f32_16x16x32_bf16 v[176:179], v[236:239], v[156:159], v[176:179]
    s_add_u32 s101, s18, 1048576
    buffer_load_dwordx4 v[120:123], v46, s[36:39], s101 offen sc1
    s_waitcnt vmcnt(13)
    v_mfma_f32_16x16x32_bf16 v[160:163], v[240:243], v[80:83], v[160:163]
    v_mfma_f32_16x16x32_bf16 v[164:167], v[244:247], v[80:83], v[164:167]
    v_mfma_f32_16x16x32_bf16 v[168:171], v[248:251], v[80:83], v[168:171]
    v_mfma_f32_16x16x32_bf16 v[172:175], v[252:255], v[80:83], v[172:175]
    v_mfma_f32_16x16x32_bf16 v[176:179], a[100:103], v[80:83], v[176:179]
    s_add_u32 s101, s18, 1179648
    buffer_load_dwordx4 v[124:127], v46, s[36:39], s101 offen sc1
    s_waitcnt vmcnt(13)
    v_mfma_f32_16x16x32_bf16 v[160:163], a[104:107], v[84:87], v[160:163]
    v_mfma_f32_16x16x32_bf16 v[164:167], a[108:111], v[84:87], v[164:167]
    v_mfma_f32_16x16x32_bf16 v[168:171], a[112:115], v[84:87], v[168:171]
    v_mfma_f32_16x16x32_bf16 v[172:175], a[116:119], v[84:87], v[172:175]
    v_mfma_f32_16x16x32_bf16 v[176:179], a[120:123], v[84:87], v[176:179]
    s_add_u32 s101, s18, 1310720
    buffer_load_dwordx4 v[128:131], v46, s[36:39], s101 offen sc1
    s_waitcnt vmcnt(13)
    v_mfma_f32_16x16x32_bf16 v[180:183], a[132:135], v[88:91], v[200:203]
    v_mfma_f32_16x16x32_bf16 v[184:187], a[136:139], v[88:91], v[204:207]
    v_mfma_f32_16x16x32_bf16 v[188:191], a[140:143], v[88:91], v[208:211]
    v_mfma_f32_16x16x32_bf16 v[192:195], a[144:147], v[88:91], v[212:215]
    v_mfma_f32_16x16x32_bf16 v[196:199], a[148:151], v[88:91], v[216:219]
    ds_write_b128 v5, v[160:163] offset:10240
    s_add_u32 s101, s18, 1441792
    buffer_load_dwordx4 v[132:135], v46, s[36:39], s101 offen sc1
    s_waitcnt vmcnt(13)
    v_mfma_f32_16x16x32_bf16 v[180:183], a[152:155], v[92:95], v[180:183]
    ds_write_b128 v5, v[164:167] offset:11264
    v_mfma_f32_16x16x32_bf16 v[184:187], a[156:159], v[92:95], v[184:187]
    ds_write_b128 v5, v[168:171] offset:12288
    v_mfma_f32_16x16x32_bf16 v[188:191], a[160:163], v[92:95], v[188:191]
    ds_write_b128 v5, v[172:175] offset:13312
    v_mfma_f32_16x16x32_bf16 v[192:195], a[164:167], v[92:95], v[192:195]
    ds_write_b128 v5, v[176:179] offset:14336
    v_mfma_f32_16x16x32_bf16 v[196:199], a[168:171], v[92:95], v[196:199]
    s_waitcnt vmcnt(8)
    s_waitcnt lgkmcnt(0)
    s_barrier
    ds_read_u16_d16_hi v68, v15 offset:0
    ds_read_u16_d16_hi v69, v15 offset:128
    ds_read_u16_d16_hi v70, v15 offset:256
    ds_read_u16_d16_hi v71, v15 offset:384
    ds_read_u16_d16_hi v72, v15 offset:512
    ds_read_u16_d16_hi v73, v15 offset:640
    ds_read_u16_d16_hi v74, v15 offset:768
    ds_read_u16_d16_hi v75, v15 offset:896
    ds_read_u16_d16_hi v76, v15 offset:4096
    ds_read_u16_d16_hi v77, v15 offset:4224
    ds_read_u16_d16_hi v78, v15 offset:4352
    ds_read_u16_d16_hi v79, v15 offset:4480
    ds_read_u16_d16_hi v34, v15 offset:4608
    ds_read_u16_d16_hi v35, v15 offset:4736
    ds_read_u16_d16_hi v36, v15 offset:4864
    ds_read_u16_d16_hi v37, v15 offset:4992
    ds_read_u16_d16_hi v38, v16 offset:8192
    ds_read_u16_d16_hi v39, v16 offset:8320
    ds_read_u16_d16_hi v40, v16 offset:8448
    ds_read_u16_d16_hi v41, v16 offset:8576
    s_add_u32 s101, s18, 1572864
    buffer_load_dwordx4 v[136:139], v46, s[36:39], s101 offen sc1
    v_mfma_f32_16x16x32_bf16 v[180:183], a[172:175], v[96:99], v[180:183]
    ds_read_b128 v[48:51], v6 offset:0
    v_mfma_f32_16x16x32_bf16 v[184:187], a[176:179], v[96:99], v[184:187]
    ds_read_b128 v[52:55], v6 offset:1024
    v_mfma_f32_16x16x32_bf16 v[188:191], a[180:183], v[96:99], v[188:191]
    ds_read_b128 v[56:59], v6 offset:2048
    v_mfma_f32_16x16x32_bf16 v[192:195], a[184:187], v[96:99], v[192:195]
    ds_read_b128 v[60:63], v6 offset:3072
    v_mfma_f32_16x16x32_bf16 v[196:199], a[188:191], v[96:99], v[196:199]
    ds_read_b128 v[64:67], v6 offset:4096
    s_add_u32 s101, s18, s19
    buffer_load_dwordx4 v[140:143], v46, s[36:39], s101 offen sc1
    v_mfma_f32_16x16x32_bf16 v[180:183], a[192:195], v[100:103], v[180:183]
    ds_read_b128 v[160:163], v7 offset:0
    v_mfma_f32_16x16x32_bf16 v[184:187], a[196:199], v[100:103], v[184:187]
    ds_read_b128 v[164:167], v7 offset:1024
    v_mfma_f32_16x16x32_bf16 v[188:191], a[200:203], v[100:103], v[188:191]
    ds_read_b128 v[168:171], v7 offset:2048
    v_mfma_f32_16x16x32_bf16 v[192:195], a[204:207], v[100:103], v[192:195]
    ds_read_b128 v[172:175], v7 offset:3072
    v_mfma_f32_16x16x32_bf16 v[196:199], a[208:211], v[100:103], v[196:199]
    ds_read_b128 v[176:179], v7 offset:4096
    s_waitcnt vmcnt(9)
    v_mfma_f32_16x16x32_bf16 v[180:183], a[212:215], v[104:107], v[180:183]
    ds_read_b128 v[144:147], v8 offset:0
    v_mfma_f32_16x16x32_bf16 v[184:187], a[216:219], v[104:107], v[184:187]
    ds_read_b128 v[148:151], v8 offset:1024
    v_mfma_f32_16x16x32_bf16 v[188:191], a[220:223], v[104:107], v[188:191]
    ds_read_b128 v[152:155], v8 offset:2048
    v_mfma_f32_16x16x32_bf16 v[192:195], a[224:227], v[104:107], v[192:195]
    ds_read_b128 v[156:159], v8 offset:3072
    v_mfma_f32_16x16x32_bf16 v[196:199], a[228:231], v[104:107], v[196:199]
    ds_read_b128 v[220:223], v8 offset:4096
    s_waitcnt vmcnt(8)
    v_mfma_f32_16x16x32_bf16 v[180:183], a[232:235], v[108:111], v[180:183]
    v_mfma_f32_16x16x32_bf16 v[184:187], a[236:239], v[108:111], v[184:187]
    v_mfma_f32_16x16x32_bf16 v[188:191], a[240:243], v[108:111], v[188:191]
    v_mfma_f32_16x16x32_bf16 v[192:195], a[244:247], v[108:111], v[192:195]
    v_mfma_f32_16x16x32_bf16 v[196:199], a[248:251], v[108:111], v[196:199]
    s_waitcnt lgkmcnt(15)
    s_waitcnt vmcnt(7)
    v_mfma_f32_16x16x32_bf16 v[180:183], a[252:255], v[112:115], v[180:183]
    v_lshlrev_b32 v10, 16, v24
    v_and_b32 v11, s63, v24
    v_mfma_f32_16x16x32_bf16 v[184:187], a[0:3], v[112:115], v[184:187]
    v_fma_f32 v10, v10, v44, v45
    v_fma_f32 v11, v11, v44, v45
    v_mfma_f32_16x16x32_bf16 v[188:191], a[4:7], v[112:115], v[188:191]
    v_mul_f32 v68, v68, v10
    v_mul_f32 v69, v69, v11
    v_mfma_f32_16x16x32_bf16 v[192:195], a[8:11], v[112:115], v[192:195]
    v_lshlrev_b32 v10, 16, v25
    v_and_b32 v11, s63, v25
    v_mfma_f32_16x16x32_bf16 v[196:199], a[12:15], v[112:115], v[196:199]
    v_fma_f32 v10, v10, v44, v45
    v_fma_f32 v11, v11, v44, v45
    s_waitcnt vmcnt(6)
    v_mfma_f32_16x16x32_bf16 v[180:183], a[16:19], v[116:119], v[180:183]
    v_mul_f32 v70, v70, v10
    v_mul_f32 v71, v71, v11
    v_mfma_f32_16x16x32_bf16 v[184:187], a[20:23], v[116:119], v[184:187]
    v_lshlrev_b32 v10, 16, v26
    v_and_b32 v11, s63, v26
    v_mfma_f32_16x16x32_bf16 v[188:191], a[24:27], v[116:119], v[188:191]
    v_fma_f32 v10, v10, v44, v45
    v_fma_f32 v11, v11, v44, v45
    v_mfma_f32_16x16x32_bf16 v[192:195], a[28:31], v[116:119], v[192:195]
    v_mul_f32 v72, v72, v10
    v_mul_f32 v73, v73, v11
    v_mfma_f32_16x16x32_bf16 v[196:199], a[32:35], v[116:119], v[196:199]
    v_lshlrev_b32 v10, 16, v27
    v_and_b32 v11, s63, v27
    s_waitcnt vmcnt(5)
    v_mfma_f32_16x16x32_bf16 v[180:183], a[36:39], v[120:123], v[180:183]
    v_fma_f32 v10, v10, v44, v45
    v_fma_f32 v11, v11, v44, v45
    v_mfma_f32_16x16x32_bf16 v[184:187], a[40:43], v[120:123], v[184:187]
    v_mul_f32 v74, v74, v10
    v_mul_f32 v75, v75, v11
    v_mfma_f32_16x16x32_bf16 v[188:191], a[44:47], v[120:123], v[188:191]
    v_lshlrev_b32 v10, 16, v28
    v_and_b32 v11, s63, v28
    v_mfma_f32_16x16x32_bf16 v[192:195], a[48:51], v[120:123], v[192:195]
    v_fma_f32 v10, v10, v44, v45
    v_fma_f32 v11, v11, v44, v45
    v_mfma_f32_16x16x32_bf16 v[196:199], a[52:55], v[120:123], v[196:199]
    v_mul_f32 v76, v76, v10
    v_mul_f32 v77, v77, v11
    s_waitcnt vmcnt(4)
    v_mfma_f32_16x16x32_bf16 v[180:183], a[56:59], v[124:127], v[180:183]
    v_lshlrev_b32 v10, 16, v29
    v_and_b32 v11, s63, v29
    v_mfma_f32_16x16x32_bf16 v[184:187], a[60:63], v[124:127], v[184:187]
    v_fma_f32 v10, v10, v44, v45
    v_fma_f32 v11, v11, v44, v45
    v_mfma_f32_16x16x32_bf16 v[188:191], a[64:67], v[124:127], v[188:191]
    v_mul_f32 v78, v78, v10
    v_mul_f32 v79, v79, v11
    v_mfma_f32_16x16x32_bf16 v[192:195], a[68:71], v[124:127], v[192:195]
    v_lshlrev_b32 v10, 16, v30
    v_and_b32 v11, s63, v30
    v_mfma_f32_16x16x32_bf16 v[196:199], a[72:75], v[124:127], v[196:199]
    v_fma_f32 v10, v10, v44, v45
    v_fma_f32 v11, v11, v44, v45
    s_waitcnt vmcnt(3)
    v_mfma_f32_16x16x32_bf16 v[180:183], a[76:79], v[128:131], v[180:183]
    v_mul_f32 v34, v34, v10
    v_mul_f32 v35, v35, v11
    v_mfma_f32_16x16x32_bf16 v[184:187], a[80:83], v[128:131], v[184:187]
    v_lshlrev_b32 v10, 16, v31
    v_and_b32 v11, s63, v31
    v_mfma_f32_16x16x32_bf16 v[188:191], a[84:87], v[128:131], v[188:191]
    v_fma_f32 v10, v10, v44, v45
    v_fma_f32 v11, v11, v44, v45
    v_mfma_f32_16x16x32_bf16 v[192:195], a[88:91], v[128:131], v[192:195]
    v_mul_f32 v36, v36, v10
    v_mul_f32 v37, v37, v11
    v_mfma_f32_16x16x32_bf16 v[196:199], a[92:95], v[128:131], v[196:199]
    v_lshlrev_b32 v10, 16, v32
    v_and_b32 v11, s63, v32
    s_waitcnt vmcnt(2)
    v_mfma_f32_16x16x32_bf16 v[180:183], a[96:99], v[132:135], v[180:183]
    v_fma_f32 v10, v10, v44, v45
    v_fma_f32 v11, v11, v44, v45
    v_mfma_f32_16x16x32_bf16 v[184:187], v[224:227], v[132:135], v[184:187]
    v_mul_f32 v38, v38, v10
    v_mul_f32 v39, v39, v11
    v_mfma_f32_16x16x32_bf16 v[188:191], v[228:231], v[132:135], v[188:191]
    v_lshlrev_b32 v10, 16, v33
    v_and_b32 v11, s63, v33
    v_mfma_f32_16x16x32_bf16 v[192:195], v[232:235], v[132:135], v[192:195]
    v_fma_f32 v10, v10, v44, v45
    v_fma_f32 v11, v11, v44, v45
    v_mfma_f32_16x16x32_bf16 v[196:199], v[236:239], v[132:135], v[196:199]
    v_mul_f32 v40, v40, v10
    v_mul_f32 v41, v41, v11
    s_waitcnt vmcnt(1)
    v_mfma_f32_16x16x32_bf16 v[180:183], v[240:243], v[136:139], v[180:183]
    v_add_u32 v10, 0, v1
    v_mul_u32_u24 v11, 6554, v10
    v_mfma_f32_16x16x32_bf16 v[184:187], v[244:247], v[136:139], v[184:187]
    v_lshrrev_b32 v11, 16, v11
    v_mul_u32_u24 v11, 1120, v11
    v_mfma_f32_16x16x32_bf16 v[188:191], v[248:251], v[136:139], v[188:191]
    v_lshl_add_u32 v13, v10, 4, v11
    v_add_u32 v10, 64, v1
    v_mfma_f32_16x16x32_bf16 v[192:195], v[252:255], v[136:139], v[192:195]
    v_mul_u32_u24 v11, 6554, v10
    v_lshrrev_b32 v11, 16, v11
    v_mfma_f32_16x16x32_bf16 v[196:199], a[100:103], v[136:139], v[196:199]
    v_mul_u32_u24 v11, 1120, v11
    v_lshl_add_u32 v14, v10, 4, v11
    s_waitcnt vmcnt(0)
    v_mfma_f32_16x16x32_bf16 v[180:183], a[104:107], v[140:143], v[180:183]
    v_add_u32 v10, 128, v1
    v_mul_u32_u24 v11, 6554, v10
    v_mfma_f32_16x16x32_bf16 v[184:187], a[108:111], v[140:143], v[184:187]
    v_lshrrev_b32 v11, 16, v11
    v_mul_u32_u24 v11, 1120, v11
    v_mfma_f32_16x16x32_bf16 v[188:191], a[112:115], v[140:143], v[188:191]
    v_lshl_add_u32 v15, v10, 4, v11
    v_add_u32 v16, s92, v4
    v_mfma_f32_16x16x32_bf16 v[192:195], a[116:119], v[140:143], v[192:195]
    v_mfma_f32_16x16x32_bf16 v[196:199], a[120:123], v[140:143], v[196:199]
    s_waitcnt lgkmcnt(0)
    v_pk_add_f32 v[48:49], v[48:49], v[160:161]
    v_pk_add_f32 v[50:51], v[50:51], v[162:163]
    v_pk_add_f32 v[52:53], v[52:53], v[164:165]
    v_pk_add_f32 v[54:55], v[54:55], v[166:167]
    v_pk_add_f32 v[56:57], v[56:57], v[168:169]
    v_pk_add_f32 v[58:59], v[58:59], v[170:171]
    v_pk_add_f32 v[60:61], v[60:61], v[172:173]
    v_pk_add_f32 v[62:63], v[62:63], v[174:175]
    v_pk_add_f32 v[64:65], v[64:65], v[176:177]
    v_pk_add_f32 v[66:67], v[66:67], v[178:179]
    v_pk_add_f32 v[48:49], v[48:49], v[144:145]
    v_pk_add_f32 v[50:51], v[50:51], v[146:147]
    v_pk_add_f32 v[52:53], v[52:53], v[148:149]
    v_pk_add_f32 v[54:55], v[54:55], v[150:151]
    v_pk_add_f32 v[56:57], v[56:57], v[152:153]
    v_pk_add_f32 v[58:59], v[58:59], v[154:155]
    v_pk_add_f32 v[60:61], v[60:61], v[156:157]
    v_pk_add_f32 v[62:63], v[62:63], v[158:159]
    v_pk_add_f32 v[64:65], v[64:65], v[220:221]
    v_pk_add_f32 v[66:67], v[66:67], v[222:223]
    v_pk_add_f32 v[180:181], v[180:181], v[48:49]
    v_pk_add_f32 v[182:183], v[182:183], v[50:51]
    v_pk_add_f32 v[184:185], v[184:185], v[52:53]
    v_pk_add_f32 v[186:187], v[186:187], v[54:55]
    v_pk_add_f32 v[188:189], v[188:189], v[56:57]
    v_pk_add_f32 v[190:191], v[190:191], v[58:59]
    v_pk_add_f32 v[192:193], v[192:193], v[60:61]
    v_pk_add_f32 v[194:195], v[194:195], v[62:63]
    v_pk_add_f32 v[196:197], v[196:197], v[64:65]
    v_pk_add_f32 v[198:199], v[198:199], v[66:67]
    v_pk_mul_f32 v[80:81], v[180:181], s[94:95] op_sel_hi:[1,0]
    v_pk_mul_f32 v[82:83], v[182:183], s[94:95] op_sel_hi:[1,0]
    v_pk_mul_f32 v[84:85], v[184:185], s[94:95] op_sel_hi:[1,0]
    v_pk_mul_f32 v[86:87], v[186:187], s[94:95] op_sel_hi:[1,0]
    v_pk_mul_f32 v[88:89], v[188:189], s[94:95] op_sel_hi:[1,0]
    v_pk_mul_f32 v[90:91], v[190:191], s[94:95] op_sel_hi:[1,0]
    v_pk_mul_f32 v[92:93], v[192:193], s[94:95] op_sel_hi:[1,0]
    v_pk_mul_f32 v[94:95], v[194:195], s[94:95] op_sel_hi:[1,0]
    v_pk_mul_f32 v[96:97], v[196:197], s[94:95] op_sel_hi:[1,0]
    v_pk_mul_f32 v[98:99], v[198:199], s[94:95] op_sel_hi:[1,0]
    v_exp_f32 v80, v80
    v_exp_f32 v81, v81
    v_exp_f32 v82, v82
    v_exp_f32 v83, v83
    v_exp_f32 v84, v84
    v_exp_f32 v85, v85
    v_exp_f32 v86, v86
    v_exp_f32 v87, v87
    v_exp_f32 v88, v88
    v_exp_f32 v89, v89
    v_exp_f32 v90, v90
    v_exp_f32 v91, v91
    v_exp_f32 v92, v92
    v_exp_f32 v93, v93
    v_exp_f32 v94, v94
    v_exp_f32 v95, v95
    v_exp_f32 v96, v96
    v_exp_f32 v97, v97
    v_exp_f32 v98, v98
    v_exp_f32 v99, v99
    v_pk_add_f32 v[80:81], v[80:81], 1.0 op_sel_hi:[1,0]
    v_pk_add_f32 v[82:83], v[82:83], 1.0 op_sel_hi:[1,0]
    v_pk_add_f32 v[84:85], v[84:85], 1.0 op_sel_hi:[1,0]
    v_pk_add_f32 v[86:87], v[86:87], 1.0 op_sel_hi:[1,0]
    v_pk_add_f32 v[88:89], v[88:89], 1.0 op_sel_hi:[1,0]
    v_pk_add_f32 v[90:91], v[90:91], 1.0 op_sel_hi:[1,0]
    v_pk_add_f32 v[92:93], v[92:93], 1.0 op_sel_hi:[1,0]
    v_pk_add_f32 v[94:95], v[94:95], 1.0 op_sel_hi:[1,0]
    v_pk_add_f32 v[96:97], v[96:97], 1.0 op_sel_hi:[1,0]
    v_pk_add_f32 v[98:99], v[98:99], 1.0 op_sel_hi:[1,0]
    v_pk_mul_f32 v[180:181], v[180:181], v[68:69]
    v_pk_mul_f32 v[182:183], v[182:183], v[70:71]
    v_pk_mul_f32 v[184:185], v[184:185], v[72:73]
    v_pk_mul_f32 v[186:187], v[186:187], v[74:75]
    v_pk_mul_f32 v[188:189], v[188:189], v[76:77]
    v_pk_mul_f32 v[190:191], v[190:191], v[78:79]
    v_pk_mul_f32 v[192:193], v[192:193], v[34:35]
    v_pk_mul_f32 v[194:195], v[194:195], v[36:37]
    v_pk_mul_f32 v[196:197], v[196:197], v[38:39]
    v_pk_mul_f32 v[198:199], v[198:199], v[40:41]
    v_rcp_f32 v80, v80
    v_rcp_f32 v81, v81
    v_rcp_f32 v82, v82
    v_rcp_f32 v83, v83
    v_rcp_f32 v84, v84
    v_rcp_f32 v85, v85
    v_rcp_f32 v86, v86
    v_rcp_f32 v87, v87
    v_rcp_f32 v88, v88
    v_rcp_f32 v89, v89
    v_rcp_f32 v90, v90
    v_rcp_f32 v91, v91
    v_rcp_f32 v92, v92
    v_rcp_f32 v93, v93
    v_rcp_f32 v94, v94
    v_rcp_f32 v95, v95
    v_rcp_f32 v96, v96
    v_rcp_f32 v97, v97
    v_rcp_f32 v98, v98
    v_rcp_f32 v99, v99
    v_lshlrev_b32 v100, 16, v24
    v_and_b32 v101, s63, v24
    v_lshlrev_b32 v102, 16, v25
    v_and_b32 v103, s63, v25
    v_lshlrev_b32 v104, 16, v26
    v_and_b32 v105, s63, v26
    v_lshlrev_b32 v106, 16, v27
    v_and_b32 v107, s63, v27
    v_pk_fma_f32 v[180:181], v[180:181], v[80:81], v[100:101]
    v_pk_fma_f32 v[182:183], v[182:183], v[82:83], v[102:103]
    v_pk_fma_f32 v[184:185], v[184:185], v[84:85], v[104:105]
    v_pk_fma_f32 v[186:187], v[186:187], v[86:87], v[106:107]
    v_cvt_pk_bf16_f32 v120, v180, v181
    v_cvt_pk_bf16_f32 v121, v182, v183
    v_cvt_pk_bf16_f32 v122, v184, v185
    v_cvt_pk_bf16_f32 v123, v186, v187
    ds_write_b128 v20, v[120:123] offset:0
    v_lshlrev_b32 v108, 16, v28
    v_and_b32 v109, s63, v28
    v_lshlrev_b32 v110, 16, v29
    v_and_b32 v111, s63, v29
    v_lshlrev_b32 v112, 16, v30
    v_and_b32 v113, s63, v30
    v_lshlrev_b32 v114, 16, v31
    v_and_b32 v115, s63, v31
    v_pk_fma_f32 v[188:189], v[188:189], v[88:89], v[108:109]
    v_pk_fma_f32 v[190:191], v[190:191], v[90:91], v[110:111]
    v_pk_fma_f32 v[192:193], v[192:193], v[92:93], v[112:113]
    v_pk_fma_f32 v[194:195], v[194:195], v[94:95], v[114:115]
    v_cvt_pk_bf16_f32 v124, v188, v189
    v_cvt_pk_bf16_f32 v125, v190, v191
    v_cvt_pk_bf16_f32 v126, v192, v193
    v_cvt_pk_bf16_f32 v127, v194, v195
    ds_write_b128 v20, v[124:127] offset:64
    v_lshlrev_b32 v116, 16, v32
    v_and_b32 v117, s63, v32
    v_lshlrev_b32 v118, 16, v33
    v_and_b32 v119, s63, v33
    v_pk_fma_f32 v[196:197], v[196:197], v[96:97], v[116:117]
    v_pk_fma_f32 v[198:199], v[198:199], v[98:99], v[118:119]
    v_cvt_pk_bf16_f32 v128, v196, v197
    v_cvt_pk_bf16_f32 v129, v198, v199
    ds_write_b64 v21, v[128:129] offset:128
    ds_read_b128 v[132:135], v16 offset:0
    ds_read_b128 v[136:139], v16 offset:1024
    ds_read_b128 v[140:143], v16 offset:2048
    s_waitcnt lgkmcnt(2)
    buffer_store_dwordx4 v[132:135], v13, s[32:35], s23 offen
    s_waitcnt lgkmcnt(1)
    buffer_store_dwordx4 v[136:139], v14, s[32:35], s23 offen
    s_waitcnt lgkmcnt(0)
    s_mov_b32 exec_hi, 0
    buffer_store_dwordx4 v[140:143], v15, s[32:35], s23 offen
    s_mov_b64 exec, -1
L_end:
    s_endpgm
.section .rodata,"a"
.p2align 6
.amdhsa_kernel recurrent_scan__ssm_conv_h3__mixer_s_mlp__prompt_kernel
  .amdhsa_next_free_vgpr 512
  .amdhsa_next_free_sgpr 102
  .amdhsa_accum_offset 256
  .amdhsa_group_segment_fixed_size 0
  .amdhsa_kernarg_size 112
  .amdhsa_user_sgpr_count 2
  .amdhsa_user_sgpr_kernarg_segment_ptr 1
  .amdhsa_system_sgpr_workgroup_id_x 1
  .amdhsa_float_denorm_mode_32 3
.end_amdhsa_kernel
```
